```python
import torch

def _softmax(x, axis=-1):
    return torch.softmax(x, dim=axis)
def _gelu(x):
    return torch.nn.functional.gelu(x, approximate="tanh")
def _silu(x):
    return torch.nn.functional.silu(x)
def _sigmoid(x):
    return torch.sigmoid(x)
def _layernorm(x, axis=-1, eps=1e-5):
    m = x.mean(dim=axis, keepdim=True)
    v = x.var(dim=axis, keepdim=True, unbiased=False)
    return (x - m) / torch.sqrt(v + eps)
def _scatter_add(tgt, idx, src, axis=0):
    return tgt.clone().index_add_(axis, idx, src)
def _segment_sum(src, seg, n):
    out = torch.zeros((n,) + src.shape[1:], dtype=src.dtype)
    return out.index_add_(0, seg, src)
def _pad(x, pw):
    flat = tuple(v for pair in reversed(pw) for v in pair)
    return torch.nn.functional.pad(x, flat)

kernel_name = 'standalone__paged_block_table_kv_radixattention__sampling'

def setup_inputs():

    _w = (lambda a: (lambda t: t.to(torch.bfloat16) if t.is_floating_point() else t)(torch.as_tensor(a)))
    B, H, Hkv, Dh = 16, 32, 16, 128
    Lk = 4096
    bs = 16
    nb = max(2, Lk // bs)
    P = max(1, nb // 2)
    n_phys = P + B * (nb - P)
    shared = torch.arange(P, dtype=torch.int64)
    priv = P + torch.arange(B * (nb - P), dtype=torch.int64).reshape(B, nb - P)
    bt = torch.cat([torch.tile(shared[None, :], (B, 1)), priv], dim=1)
    ctx = nb * bs - (torch.arange(1, B + 1, dtype=torch.int64) * 2654435761) % max(1, (nb * bs - P * bs) // 2)
    return {
        "q": _w((lambda *s: torch.randn(*s, dtype=torch.bfloat16) * 0.8)(B, H, Dh)),
        "k_cache": _w((lambda *s: torch.randn(*s, dtype=torch.bfloat16) * 0.8)(n_phys, bs, Hkv, Dh)),
        "v_cache": _w((lambda *s: torch.randn(*s, dtype=torch.bfloat16) * 0.05)(n_phys, bs, Hkv, Dh)),
        "block_table": _w(bt.to(torch.int64)),
        "ctx_lens": _w(torch.as_tensor(ctx).to(torch.int64)),
    }

def reference(q, k_cache, v_cache, block_table, ctx_lens):
    B, H, Dh = q.shape
    n_phys, bs, Hkv, _ = k_cache.shape
    nb = block_table.shape[1]
    Lk = nb * bs
    rep = H // Hkv
    k = k_cache[block_table].reshape(B, Lk, Hkv, Dh)
    v = v_cache[block_table].reshape(B, Lk, Hkv, Dh)
    k = (lambda x, n, axis: torch.repeat_interleave(x, n, dim=axis))(k, rep, axis=2)
    v = (lambda x, n, axis: torch.repeat_interleave(x, n, dim=axis))(v, rep, axis=2)
    scores = torch.einsum("bhd,bkhd->bhk", q, k) * (Dh ** -0.5)
    pos = torch.arange(Lk)
    valid = pos[None, :] < ctx_lens[:, None]
    scores = torch.where(valid[:, None, :], scores, -1e9)
    p = _softmax(scores, axis=-1)
    return torch.einsum("bhk,bkhd->bhd", p, v)
```

```asm
; @launch grid=(256,1,1) block=(320,1,1) lds=152320
.amdgcn_target "amdgcn-amd-amdhsa--gfx950"
.text
.globl standalone__paged_block_table_kv_radixattention__sampling_kernel
.p2align 8
.type standalone__paged_block_table_kv_radixattention__sampling_kernel,@function
standalone__paged_block_table_kv_radixattention__sampling_kernel:
    s_cmp_ge_u32 s2, 256
    s_cbranch_scc1 L_exit
    s_load_dwordx16 s[4:19], s[0:1], 0
    v_lshrrev_b32 v8, 6, v0
    v_and_b32 v1, 63, v0
    v_readfirstlane_b32 s3, v8
    s_and_b32 s36, s2, 7
    s_lshl_b32 s36, s36, 1
    s_bfe_u32 s54, s2, 65539
    s_or_b32 s36, s36, s54
    s_lshr_b32 s37, s2, 4
    s_getpc_b64 s[66:67]
L_pc:
    v_lshlrev_b32 v9, 7, v0
    v_min_u32 v9, L_hint-L_pc, v9
    global_load_dword v175, v9, s[66:67]
    s_mov_b32 m0, s37
    s_mov_b32 s76, 0x445700ab
    s_mov_b32 s77, 0x44570110
    s_mov_b32 s78, 0x445501b4
    s_mov_b32 s79, 0x44290200
    s_mov_b32 s80, 0x440f0298
    s_mov_b32 s81, 0x44150300
    s_mov_b32 s82, 0x444b0380
    s_mov_b32 s83, 0x440f0407
    s_mov_b32 s84, 0x44370480
    s_mov_b32 s85, 0x440f0511
    s_mov_b32 s86, 0x44230580
    s_mov_b32 s87, 0x440f061b
    s_mov_b32 s88, 0x440f0680
    s_mov_b32 s89, 0x44430700
    s_mov_b32 s90, 0x440f0789
    s_mov_b32 s91, 0x8010080
    s_movrels_b32 s68, s76
    s_cmp_eq_u32 s3, 3
    s_cbranch_scc1 L_service
    s_mul_i32 s56, s3, 131073
    s_lshl_b32 s38, s36, 8
    v_and_b32 v10, 15, v1
    v_lshrrev_b32 v11, 4, v1
    v_lshrrev_b32 v12, 1, v10
    v_lshlrev_b32 v2, 12, v12
    v_lshl_add_u32 v2, v11, 5, v2
    v_and_b32 v8, 1, v1
    v_lshl_add_u32 v2, v8, 4, v2
    v_lshlrev_b32 v3, 13, v11
    v_lshl_add_u32 v3, v10, 4, v3
    s_mov_b32 s22, 142606336
    s_mov_b32 s23, 0x20000
    v_and_b32 v15, 0x70, v2
    s_lshl_b32 s54, s36, 9
    v_lshrrev_b32 v14, 3, v10
    v_lshl_add_u32 v14, v14, 8, v15
    v_add_u32 v14, s54, v14
    s_cmp_gt_u32 s3, 3
    s_cbranch_scc1 L_boost
    s_lshr_b32 s42, s68, 26
    s_sub_u32 s54, s42, 2
    s_and_b32 s54, s54, 15
    s_cmp_eq_u32 s42, 17
    s_cselect_b32 s54, s37, s54
    s_lshl_b32 s54, s54, 13
    v_add_u32 v14, s54, v14
    s_add_u32 s45, s68, s56
    s_add_u32 s46, s45, 393219
    s_add_u32 s24, s46, 393219
    s_add_u32 s68, s24, 393219
    s_mov_b32 s69, 128
    v_mov_b32 v16, v2
    s_and_b32 s48, s45, 0xfff
    s_lshl_b32 s48, s48, 16
    s_and_b32 s22, s45, 0x1f000
    s_add_u32 s22, s22, s48
    s_add_u32 s48, s48, s38
    s_add_u32 s50, s48, 32768
    s_add_u32 s49, s48, s69
    s_add_u32 s51, s50, s69
    s_waitcnt lgkmcnt(0)
    s_mov_b64 s[20:21], s[6:7]
    buffer_load_dwordx4 v[128:131], v16, s[20:23], s48 offen nt
    buffer_load_dwordx4 v[132:135], v16, s[20:23], s49 offen nt
    buffer_load_dwordx4 v[136:139], v16, s[20:23], s50 offen nt
    buffer_load_dwordx4 v[140:143], v16, s[20:23], s51 offen nt
    global_load_dwordx4 v[64:67], v14, s[4:5]
    global_load_dwordx4 v[68:71], v14, s[4:5] offset:128
    s_and_b32 s48, s46, 0xfff
    s_lshl_b32 s48, s48, 16
    s_and_b32 s22, s46, 0x1f000
    s_add_u32 s22, s22, s48
    s_add_u32 s48, s48, s38
    s_add_u32 s50, s48, 32768
    s_add_u32 s49, s48, s69
    s_add_u32 s51, s50, s69
    buffer_load_dwordx4 v[144:147], v16, s[20:23], s48 offen nt
    buffer_load_dwordx4 v[148:151], v16, s[20:23], s49 offen nt
    buffer_load_dwordx4 v[152:155], v16, s[20:23], s50 offen nt
    buffer_load_dwordx4 v[156:159], v16, s[20:23], s51 offen nt
    s_and_b32 s48, s24, 0xfff
    s_lshl_b32 s48, s48, 16
    s_and_b32 s22, s24, 0x1f000
    s_add_u32 s22, s22, s48
    s_add_u32 s48, s48, s38
    s_add_u32 s50, s48, 32768
    s_add_u32 s49, s48, s69
    s_add_u32 s51, s50, s69
    v_lshlrev_b32 v4, 1, v11
    v_lshlrev_b32 v8, 4, v8
    v_mov_b32 v9, 0xffff
    v_lshlrev_b32 v5, v8, v9
    v_mov_b32 v6, 8256
    v_mov_b32 v7, 1
    s_mov_b32 s39, 0x3e0293ee
    s_mov_b32 s53, 0
    s_mov_b32 s52, 3
    s_mov_b32 s40, 0
    s_and_b32 s70, s36, 3
    s_cmp_lg_u32 s70, 1
    s_cselect_b32 s70, 1, 0
    s_mov_b32 s72, s70
    s_mov_b32 s25, 1
    s_mov_b32 s26, 0
    s_mov_b32 s27, 0
    v_and_b32 v17, 0x38, v1
    v_lshlrev_b32 v17, 1, v17
    v_add_u32 v17, 29952, v17
    v_lshrrev_b32 v18, 1, v1
    v_lshlrev_b32 v18, 4, v18
    v_add_u32 v18, 64256, v18
    v_and_b32 v60, 1, v1
    v_lshl_add_u32 v60, v60, 10, v18
    v_bfe_u32 v8, v1, 1, 2
    v_cmp_eq_u32 vcc, 0, v8
    s_nop 1
    v_cndmask_b32 v20, 0, v5, vcc
    v_cmp_eq_u32 vcc, 1, v8
    s_nop 1
    v_cndmask_b32 v21, 0, v5, vcc
    v_cmp_eq_u32 vcc, 2, v8
    s_nop 1
    v_cndmask_b32 v22, 0, v5, vcc
    v_cmp_eq_u32 vcc, 3, v8
    s_nop 1
    v_cndmask_b32 v23, 0, v5, vcc
    s_barrier
    s_nop 0
L_kp_0:
    s_lshr_b32 s54, s45, 26
    s_cmp_lg_u32 s54, s42
    s_cbranch_scc1 L_switch_0
    s_bfe_u32 s57, s45, 589841
    s_cmp_lt_u32 s52, 12
    s_cbranch_scc1 L_g_1
    s_cmp_lg_u32 s53, 0
    s_cbranch_scc1 L_sy_2
L_sy_3:
    v_mov_b32 v14, 8192
    ds_read_b32 v14, v14
    s_mov_b32 s53, 1
    s_waitcnt lgkmcnt(0)
    v_readfirstlane_b32 s41, v14
    s_nop 0
    s_cmp_eq_u32 s41, 0
    s_nop 1
    s_cbranch_scc1 L_sy_3
    s_bfe_u32 s40, s41, 655378
    s_bitcmp0_b32 s41, 31
    s_cbranch_scc1 L_restart
L_sy_2:
    s_mov_b64 exec, 1
    ds_add_rtn_u32 v0, v6, v7
    s_mov_b64 exec, -1
L_g_1:
    s_waitcnt vmcnt(8)
    s_cmp_eq_u32 s70, 2
    s_cbranch_scc1 L_wi_4
    s_waitcnt vmcnt(4)
    s_cmp_lg_u32 s70, 0
    s_cbranch_scc1 L_wi_4
    buffer_load_dwordx4 v[160:163], v16, s[20:23], s48 offen nt
    buffer_load_dwordx4 v[164:167], v16, s[20:23], s49 offen nt
    buffer_load_dwordx4 v[168:171], v16, s[20:23], s50 offen nt
    buffer_load_dwordx4 v[172:175], v16, s[20:23], s51 offen nt
L_wi_4:
    v_mfma_f32_16x16x32_bf16 v[24:27], v[128:131], v[64:67], 0
    v_mfma_f32_16x16x32_bf16 v[28:31], v[136:139], v[64:67], 0
    v_mfma_f32_16x16x32_bf16 v[24:27], v[132:135], v[68:71], v[24:27]
    v_mfma_f32_16x16x32_bf16 v[28:31], v[140:143], v[68:71], v[28:31]
    s_lshl_b32 s56, s57, 7
    v_add_u32 v8, s56, v17
    s_waitcnt lgkmcnt(0)
    v_min_u32 v0, s40, v0
    v_lshlrev_b32 v0, 2, v0
    ds_read_b32 v0, v0 offset:10240
    s_nop 0
    v_add_f32_dpp v40, v25, v24 quad_perm:[1,1,3,3] row_mask:0xf bank_mask:0xf
    v_add_f32_dpp v41, v27, v26 quad_perm:[1,1,3,3] row_mask:0xf bank_mask:0xf
    v_add_f32_dpp v42, v29, v28 quad_perm:[1,1,3,3] row_mask:0xf bank_mask:0xf
    v_add_f32_dpp v43, v31, v30 quad_perm:[1,1,3,3] row_mask:0xf bank_mask:0xf
    s_bfe_u32 s54, s45, 327692
    s_cmp_ge_u32 s54, 16
    s_cbranch_scc1 L_nomask_0
    v_mov_b32 v9, 0xd0000000
    s_sub_i32 s55, s54, 0
    v_cmp_gt_i32 vcc, s55, v4
    s_nop 1
    v_cndmask_b32 v40, v9, v40, vcc
    s_sub_i32 s55, s54, 1
    v_cmp_gt_i32 vcc, s55, v4
    s_nop 1
    v_cndmask_b32 v41, v9, v41, vcc
    s_sub_i32 s55, s54, 8
    v_cmp_gt_i32 vcc, s55, v4
    s_nop 1
    v_cndmask_b32 v42, v9, v42, vcc
    s_sub_i32 s55, s54, 9
    v_cmp_gt_i32 vcc, s55, v4
    s_nop 1
    v_cndmask_b32 v43, v9, v43, vcc
    s_nop 1
L_nomask_0:
    s_mov_b32 exec_lo, 0x01010101
    s_mov_b32 exec_hi, 0x01010101
    ds_write_b128 v8, v[40:43]
    s_lshl_b32 s55, s57, 2
    v_mov_b32 v9, s55
    v_mov_b32 v10, s25
    s_mov_b64 exec, 1
    ds_write_b32 v9, v10 offset:8448
    s_mov_b64 exec, -1
    s_waitcnt lgkmcnt(0)
    v_readfirstlane_b32 s47, v0
    s_cmp_lt_u32 s52, 12
    s_cselect_b32 s47, s68, s47
    s_addc_u32 s52, s52, 0
    s_add_u32 s68, s68, 393219
    s_cmp_lg_u32 s70, 1
    s_cbranch_scc1 L_cl_5
    buffer_load_dwordx4 v[160:163], v16, s[20:23], s48 offen nt
    buffer_load_dwordx4 v[164:167], v16, s[20:23], s49 offen nt
    buffer_load_dwordx4 v[168:171], v16, s[20:23], s50 offen nt
    buffer_load_dwordx4 v[172:175], v16, s[20:23], s51 offen nt
L_cl_5:
    s_mov_b32 s45, s46
    s_mov_b32 s46, s24
    s_mov_b32 s24, s47
    s_mov_b32 s70, s72
    s_bitcmp1_b32 s24, 31
    s_cbranch_scc1 L_ph_6
L_ph_7:
    s_and_b32 s48, s24, 0xfff
    s_lshl_b32 s48, s48, 16
    s_and_b32 s22, s24, 0x1f000
    s_add_u32 s22, s22, s48
    s_add_u32 s48, s48, s38
    s_add_u32 s50, s48, 32768
    s_add_u32 s49, s48, s69
    s_add_u32 s51, s50, s69
L_kp_1:
    s_lshr_b32 s54, s45, 26
    s_cmp_lg_u32 s54, s42
    s_cbranch_scc1 L_switch_1
    s_bfe_u32 s57, s45, 589841
    s_cmp_lt_u32 s52, 12
    s_cbranch_scc1 L_g_8
    s_cmp_lg_u32 s53, 0
    s_cbranch_scc1 L_sy_9
L_sy_10:
    v_mov_b32 v14, 8192
    ds_read_b32 v14, v14
    s_mov_b32 s53, 1
    s_waitcnt lgkmcnt(0)
    v_readfirstlane_b32 s41, v14
    s_nop 0
    s_cmp_eq_u32 s41, 0
    s_nop 1
    s_cbranch_scc1 L_sy_10
    s_bfe_u32 s40, s41, 655378
    s_bitcmp0_b32 s41, 31
    s_cbranch_scc1 L_restart
L_sy_9:
    s_mov_b64 exec, 1
    ds_add_rtn_u32 v0, v6, v7
    s_mov_b64 exec, -1
L_g_8:
    s_waitcnt vmcnt(8)
    s_cmp_eq_u32 s70, 2
    s_cbranch_scc1 L_wi_11
    s_waitcnt vmcnt(4)
    buffer_load_dwordx4 v[128:131], v16, s[20:23], s48 offen nt
    buffer_load_dwordx4 v[132:135], v16, s[20:23], s49 offen nt
    buffer_load_dwordx4 v[136:139], v16, s[20:23], s50 offen nt
    buffer_load_dwordx4 v[140:143], v16, s[20:23], s51 offen nt
L_wi_11:
    v_mfma_f32_16x16x32_bf16 v[24:27], v[144:147], v[64:67], 0
    v_mfma_f32_16x16x32_bf16 v[28:31], v[152:155], v[64:67], 0
    v_mfma_f32_16x16x32_bf16 v[24:27], v[148:151], v[68:71], v[24:27]
    v_mfma_f32_16x16x32_bf16 v[28:31], v[156:159], v[68:71], v[28:31]
    s_lshl_b32 s56, s57, 7
    v_add_u32 v8, s56, v17
    s_waitcnt lgkmcnt(0)
    v_min_u32 v0, s40, v0
    v_lshlrev_b32 v0, 2, v0
    ds_read_b32 v0, v0 offset:10240
    s_nop 0
    v_add_f32_dpp v40, v25, v24 quad_perm:[1,1,3,3] row_mask:0xf bank_mask:0xf
    v_add_f32_dpp v41, v27, v26 quad_perm:[1,1,3,3] row_mask:0xf bank_mask:0xf
    v_add_f32_dpp v42, v29, v28 quad_perm:[1,1,3,3] row_mask:0xf bank_mask:0xf
    v_add_f32_dpp v43, v31, v30 quad_perm:[1,1,3,3] row_mask:0xf bank_mask:0xf
    s_bfe_u32 s54, s45, 327692
    s_cmp_ge_u32 s54, 16
    s_cbranch_scc1 L_nomask_1
    v_mov_b32 v9, 0xd0000000
    s_sub_i32 s55, s54, 0
    v_cmp_gt_i32 vcc, s55, v4
    s_nop 1
    v_cndmask_b32 v40, v9, v40, vcc
    s_sub_i32 s55, s54, 1
    v_cmp_gt_i32 vcc, s55, v4
    s_nop 1
    v_cndmask_b32 v41, v9, v41, vcc
    s_sub_i32 s55, s54, 8
    v_cmp_gt_i32 vcc, s55, v4
    s_nop 1
    v_cndmask_b32 v42, v9, v42, vcc
    s_sub_i32 s55, s54, 9
    v_cmp_gt_i32 vcc, s55, v4
    s_nop 1
    v_cndmask_b32 v43, v9, v43, vcc
    s_nop 1
L_nomask_1:
    s_mov_b32 exec_lo, 0x01010101
    s_mov_b32 exec_hi, 0x01010101
    ds_write_b128 v8, v[40:43]
    s_lshl_b32 s55, s57, 2
    v_mov_b32 v9, s55
    v_mov_b32 v10, s25
    s_mov_b64 exec, 1
    ds_write_b32 v9, v10 offset:8448
    s_mov_b64 exec, -1
    s_waitcnt lgkmcnt(0)
    v_readfirstlane_b32 s47, v0
    s_cmp_lt_u32 s52, 12
    s_cselect_b32 s47, s68, s47
    s_addc_u32 s52, s52, 0
    s_add_u32 s68, s68, 393219
    s_mov_b32 s45, s46
    s_mov_b32 s46, s24
    s_mov_b32 s24, s47
    s_mov_b32 s70, s72
    s_bitcmp1_b32 s24, 31
    s_cbranch_scc1 L_ph_12
L_ph_13:
    s_and_b32 s48, s24, 0xfff
    s_lshl_b32 s48, s48, 16
    s_and_b32 s22, s24, 0x1f000
    s_add_u32 s22, s22, s48
    s_add_u32 s48, s48, s38
    s_add_u32 s50, s48, 32768
    s_add_u32 s49, s48, s69
    s_add_u32 s51, s50, s69
L_kp_2:
    s_lshr_b32 s54, s45, 26
    s_cmp_lg_u32 s54, s42
    s_cbranch_scc1 L_switch_2
    s_bfe_u32 s57, s45, 589841
    s_cmp_lt_u32 s52, 12
    s_cbranch_scc1 L_g_14
    s_cmp_lg_u32 s53, 0
    s_cbranch_scc1 L_sy_15
L_sy_16:
    v_mov_b32 v14, 8192
    ds_read_b32 v14, v14
    s_mov_b32 s53, 1
    s_waitcnt lgkmcnt(0)
    v_readfirstlane_b32 s41, v14
    s_nop 0
    s_cmp_eq_u32 s41, 0
    s_nop 1
    s_cbranch_scc1 L_sy_16
    s_bfe_u32 s40, s41, 655378
    s_bitcmp0_b32 s41, 31
    s_cbranch_scc1 L_restart
L_sy_15:
    s_mov_b64 exec, 1
    ds_add_rtn_u32 v0, v6, v7
    s_mov_b64 exec, -1
L_g_14:
    s_waitcnt vmcnt(8)
    s_cmp_eq_u32 s70, 2
    s_cbranch_scc1 L_wi_17
    s_waitcnt vmcnt(4)
    buffer_load_dwordx4 v[144:147], v16, s[20:23], s48 offen nt
    buffer_load_dwordx4 v[148:151], v16, s[20:23], s49 offen nt
    buffer_load_dwordx4 v[152:155], v16, s[20:23], s50 offen nt
    buffer_load_dwordx4 v[156:159], v16, s[20:23], s51 offen nt
L_wi_17:
    v_mfma_f32_16x16x32_bf16 v[24:27], v[160:163], v[64:67], 0
    v_mfma_f32_16x16x32_bf16 v[28:31], v[168:171], v[64:67], 0
    v_mfma_f32_16x16x32_bf16 v[24:27], v[164:167], v[68:71], v[24:27]
    v_mfma_f32_16x16x32_bf16 v[28:31], v[172:175], v[68:71], v[28:31]
    s_lshl_b32 s56, s57, 7
    v_add_u32 v8, s56, v17
    s_waitcnt lgkmcnt(0)
    v_min_u32 v0, s40, v0
    v_lshlrev_b32 v0, 2, v0
    ds_read_b32 v0, v0 offset:10240
    s_nop 0
    v_add_f32_dpp v40, v25, v24 quad_perm:[1,1,3,3] row_mask:0xf bank_mask:0xf
    v_add_f32_dpp v41, v27, v26 quad_perm:[1,1,3,3] row_mask:0xf bank_mask:0xf
    v_add_f32_dpp v42, v29, v28 quad_perm:[1,1,3,3] row_mask:0xf bank_mask:0xf
    v_add_f32_dpp v43, v31, v30 quad_perm:[1,1,3,3] row_mask:0xf bank_mask:0xf
    s_bfe_u32 s54, s45, 327692
    s_cmp_ge_u32 s54, 16
    s_cbranch_scc1 L_nomask_2
    v_mov_b32 v9, 0xd0000000
    s_sub_i32 s55, s54, 0
    v_cmp_gt_i32 vcc, s55, v4
    s_nop 1
    v_cndmask_b32 v40, v9, v40, vcc
    s_sub_i32 s55, s54, 1
    v_cmp_gt_i32 vcc, s55, v4
    s_nop 1
    v_cndmask_b32 v41, v9, v41, vcc
    s_sub_i32 s55, s54, 8
    v_cmp_gt_i32 vcc, s55, v4
    s_nop 1
    v_cndmask_b32 v42, v9, v42, vcc
    s_sub_i32 s55, s54, 9
    v_cmp_gt_i32 vcc, s55, v4
    s_nop 1
    v_cndmask_b32 v43, v9, v43, vcc
    s_nop 1
L_nomask_2:
    s_mov_b32 exec_lo, 0x01010101
    s_mov_b32 exec_hi, 0x01010101
    ds_write_b128 v8, v[40:43]
    s_lshl_b32 s55, s57, 2
    v_mov_b32 v9, s55
    v_mov_b32 v10, s25
    s_mov_b64 exec, 1
    ds_write_b32 v9, v10 offset:8448
    s_mov_b64 exec, -1
    s_waitcnt lgkmcnt(0)
    v_readfirstlane_b32 s47, v0
    s_cmp_lt_u32 s52, 12
    s_cselect_b32 s47, s68, s47
    s_addc_u32 s52, s52, 0
    s_add_u32 s68, s68, 393219
    s_mov_b32 s45, s46
    s_mov_b32 s46, s24
    s_mov_b32 s24, s47
    s_mov_b32 s70, s72
    s_bitcmp1_b32 s24, 31
    s_cbranch_scc1 L_ph_18
L_ph_19:
    s_and_b32 s48, s24, 0xfff
    s_lshl_b32 s48, s48, 16
    s_and_b32 s22, s24, 0x1f000
    s_add_u32 s22, s22, s48
    s_add_u32 s48, s48, s38
    s_add_u32 s50, s48, 32768
    s_add_u32 s49, s48, s69
    s_add_u32 s51, s50, s69
    s_branch L_kp_0
L_vp_0:
    s_lshr_b32 s54, s45, 26
    s_cmp_lg_u32 s54, s42
    s_cbranch_scc1 L_switch_0
    s_bfe_u32 s57, s45, 589841
    s_mov_b64 exec, 1
    ds_add_rtn_u32 v0, v6, v7
    s_mov_b64 exec, -1
    s_lshl_b32 s55, s57, 2
    s_lshl_b32 s56, s57, 7
    v_mov_b32 v11, s55
    v_add_u32 v10, s56, v17
    ds_read_b32 v19, v11 offset:8448
    ds_read_b128 v[40:43], v10 offset:0
L_rs_vp_0:
    s_waitcnt lgkmcnt(0)
    v_readfirstlane_b32 s55, v19
    s_nop 0
    s_cmp_lg_u32 s55, s25
    s_nop 1
    s_cbranch_scc1 L_rr_vp_0
    v_min_u32 v0, s40, v0
    v_lshlrev_b32 v0, 2, v0
    ds_read_b32 v0, v0 offset:10240
    v_max3_f32 v8, v40, v41, v42
    v_max_f32 v8, v8, v43
    v_fma_f32 v12, v8, s39, -v56
    v_cmp_lt_f32 vcc, 0x40c00000, v12
    s_nop 0
    s_cmp_lg_u64 vcc, 0
    s_nop 1
    s_cbranch_scc1 L_rare_p0
L_back_p0:
    v_fma_f32 v40, v40, s39, -v56
    v_fma_f32 v41, v41, s39, -v56
    v_fma_f32 v42, v42, s39, -v56
    v_fma_f32 v43, v43, s39, -v56
    v_exp_f32 v40, v40
    v_exp_f32 v41, v41
    v_exp_f32 v42, v42
    v_exp_f32 v43, v43
    v_add_f32 v8, v40, v41
    v_add_f32 v9, v42, v43
    v_cvt_pk_bf16_f32 v40, v40, v40
    v_cvt_pk_bf16_f32 v41, v41, v41
    v_add_f32 v57, v57, v8
    v_cvt_pk_bf16_f32 v42, v42, v42
    v_cvt_pk_bf16_f32 v43, v43, v43
    v_add_f32 v57, v57, v9
    v_and_b32 v24, v40, v20
    v_and_b32 v25, v40, v21
    v_and_b32 v26, v40, v22
    v_and_b32 v27, v40, v23
    v_and_b32 v28, v41, v20
    v_and_b32 v29, v41, v21
    v_and_b32 v30, v41, v22
    v_and_b32 v31, v41, v23
    v_and_b32 v32, v42, v20
    v_and_b32 v33, v42, v21
    v_and_b32 v34, v42, v22
    v_and_b32 v35, v42, v23
    v_and_b32 v36, v43, v20
    v_and_b32 v37, v43, v21
    v_and_b32 v38, v43, v22
    v_and_b32 v39, v43, v23
    s_waitcnt vmcnt(8)
    s_cmp_eq_u32 s70, 2
    s_cbranch_scc1 L_wi_20
    s_waitcnt vmcnt(4)
    s_cmp_lg_u32 s70, 0
    s_cbranch_scc1 L_wi_20
    buffer_load_dwordx4 v[160:163], v16, s[20:23], s48 offen nt
    buffer_load_dwordx4 v[164:167], v16, s[20:23], s49 offen nt
    buffer_load_dwordx4 v[168:171], v16, s[20:23], s50 offen nt
    buffer_load_dwordx4 v[172:175], v16, s[20:23], s51 offen nt
L_wi_20:
    v_mfma_f32_16x16x32_bf16 v[64:67], v[128:131], v[24:27], v[64:67]
    v_mfma_f32_16x16x32_bf16 v[64:67], v[132:135], v[28:31], v[64:67]
    v_mfma_f32_16x16x32_bf16 v[64:67], v[136:139], v[32:35], v[64:67]
    v_mfma_f32_16x16x32_bf16 v[64:67], v[140:143], v[36:39], v[64:67]
    s_cmp_ge_u32 s46, s71
    s_cbranch_scc1 L_fast_exit
    s_waitcnt lgkmcnt(0)
    v_readfirstlane_b32 s47, v0
    s_cmp_lg_u32 s70, 1
    s_nop 3
    s_cbranch_scc1 L_cl_21
    buffer_load_dwordx4 v[160:163], v16, s[20:23], s48 offen nt
    buffer_load_dwordx4 v[164:167], v16, s[20:23], s49 offen nt
    buffer_load_dwordx4 v[168:171], v16, s[20:23], s50 offen nt
    buffer_load_dwordx4 v[172:175], v16, s[20:23], s51 offen nt
L_cl_21:
    s_mov_b32 s45, s46
    s_mov_b32 s46, s24
    s_mov_b32 s24, s47
    s_mov_b32 s70, s72
    s_and_b32 s48, s24, 0xfff
    s_lshl_b32 s48, s48, 16
    s_and_b32 s22, s24, 0x1f000
    s_add_u32 s22, s22, s48
    s_add_u32 s48, s48, s38
    s_add_u32 s50, s48, 32768
    s_add_u32 s49, s48, s69
    s_add_u32 s51, s50, s69
L_vp_1:
    s_lshr_b32 s54, s45, 26
    s_cmp_lg_u32 s54, s42
    s_cbranch_scc1 L_switch_1
    s_bfe_u32 s57, s45, 589841
    s_mov_b64 exec, 1
    ds_add_rtn_u32 v0, v6, v7
    s_mov_b64 exec, -1
    s_lshl_b32 s55, s57, 2
    s_lshl_b32 s56, s57, 7
    v_mov_b32 v11, s55
    v_add_u32 v10, s56, v17
    ds_read_b32 v19, v11 offset:8448
    ds_read_b128 v[40:43], v10 offset:0
L_rs_vp_1:
    s_waitcnt lgkmcnt(0)
    v_readfirstlane_b32 s55, v19
    s_nop 0
    s_cmp_lg_u32 s55, s25
    s_nop 1
    s_cbranch_scc1 L_rr_vp_1
    v_min_u32 v0, s40, v0
    v_lshlrev_b32 v0, 2, v0
    ds_read_b32 v0, v0 offset:10240
    v_max3_f32 v8, v40, v41, v42
    v_max_f32 v8, v8, v43
    v_fma_f32 v12, v8, s39, -v56
    v_cmp_lt_f32 vcc, 0x40c00000, v12
    s_nop 0
    s_cmp_lg_u64 vcc, 0
    s_nop 1
    s_cbranch_scc1 L_rare_p1
L_back_p1:
    v_fma_f32 v40, v40, s39, -v56
    v_fma_f32 v41, v41, s39, -v56
    v_fma_f32 v42, v42, s39, -v56
    v_fma_f32 v43, v43, s39, -v56
    v_exp_f32 v40, v40
    v_exp_f32 v41, v41
    v_exp_f32 v42, v42
    v_exp_f32 v43, v43
    v_add_f32 v8, v40, v41
    v_add_f32 v9, v42, v43
    v_cvt_pk_bf16_f32 v40, v40, v40
    v_cvt_pk_bf16_f32 v41, v41, v41
    v_add_f32 v57, v57, v8
    v_cvt_pk_bf16_f32 v42, v42, v42
    v_cvt_pk_bf16_f32 v43, v43, v43
    v_add_f32 v57, v57, v9
    v_and_b32 v24, v40, v20
    v_and_b32 v25, v40, v21
    v_and_b32 v26, v40, v22
    v_and_b32 v27, v40, v23
    v_and_b32 v28, v41, v20
    v_and_b32 v29, v41, v21
    v_and_b32 v30, v41, v22
    v_and_b32 v31, v41, v23
    v_and_b32 v32, v42, v20
    v_and_b32 v33, v42, v21
    v_and_b32 v34, v42, v22
    v_and_b32 v35, v42, v23
    v_and_b32 v36, v43, v20
    v_and_b32 v37, v43, v21
    v_and_b32 v38, v43, v22
    v_and_b32 v39, v43, v23
    s_waitcnt vmcnt(8)
    s_cmp_eq_u32 s70, 2
    s_cbranch_scc1 L_wi_22
    s_waitcnt vmcnt(4)
    s_cmp_lg_u32 s70, 0
    s_cbranch_scc1 L_wi_22
    buffer_load_dwordx4 v[128:131], v16, s[20:23], s48 offen nt
    buffer_load_dwordx4 v[132:135], v16, s[20:23], s49 offen nt
    buffer_load_dwordx4 v[136:139], v16, s[20:23], s50 offen nt
    buffer_load_dwordx4 v[140:143], v16, s[20:23], s51 offen nt
L_wi_22:
    v_mfma_f32_16x16x32_bf16 v[64:67], v[144:147], v[24:27], v[64:67]
    v_mfma_f32_16x16x32_bf16 v[64:67], v[148:151], v[28:31], v[64:67]
    v_mfma_f32_16x16x32_bf16 v[64:67], v[152:155], v[32:35], v[64:67]
    v_mfma_f32_16x16x32_bf16 v[64:67], v[156:159], v[36:39], v[64:67]
    s_cmp_ge_u32 s46, s71
    s_cbranch_scc1 L_fast_exit
    s_waitcnt lgkmcnt(0)
    v_readfirstlane_b32 s47, v0
    s_cmp_lg_u32 s70, 1
    s_nop 3
    s_cbranch_scc1 L_cl_23
    buffer_load_dwordx4 v[128:131], v16, s[20:23], s48 offen nt
    buffer_load_dwordx4 v[132:135], v16, s[20:23], s49 offen nt
    buffer_load_dwordx4 v[136:139], v16, s[20:23], s50 offen nt
    buffer_load_dwordx4 v[140:143], v16, s[20:23], s51 offen nt
L_cl_23:
    s_mov_b32 s45, s46
    s_mov_b32 s46, s24
    s_mov_b32 s24, s47
    s_mov_b32 s70, s72
    s_and_b32 s48, s24, 0xfff
    s_lshl_b32 s48, s48, 16
    s_and_b32 s22, s24, 0x1f000
    s_add_u32 s22, s22, s48
    s_add_u32 s48, s48, s38
    s_add_u32 s50, s48, 32768
    s_add_u32 s49, s48, s69
    s_add_u32 s51, s50, s69
L_vp_2:
    s_lshr_b32 s54, s45, 26
    s_cmp_lg_u32 s54, s42
    s_cbranch_scc1 L_switch_2
    s_bfe_u32 s57, s45, 589841
    s_mov_b64 exec, 1
    ds_add_rtn_u32 v0, v6, v7
    s_mov_b64 exec, -1
    s_lshl_b32 s55, s57, 2
    s_lshl_b32 s56, s57, 7
    v_mov_b32 v11, s55
    v_add_u32 v10, s56, v17
    ds_read_b32 v19, v11 offset:8448
    ds_read_b128 v[40:43], v10 offset:0
L_rs_vp_2:
    s_waitcnt lgkmcnt(0)
    v_readfirstlane_b32 s55, v19
    s_nop 0
    s_cmp_lg_u32 s55, s25
    s_nop 1
    s_cbranch_scc1 L_rr_vp_2
    v_min_u32 v0, s40, v0
    v_lshlrev_b32 v0, 2, v0
    ds_read_b32 v0, v0 offset:10240
    v_max3_f32 v8, v40, v41, v42
    v_max_f32 v8, v8, v43
    v_fma_f32 v12, v8, s39, -v56
    v_cmp_lt_f32 vcc, 0x40c00000, v12
    s_nop 0
    s_cmp_lg_u64 vcc, 0
    s_nop 1
    s_cbranch_scc1 L_rare_p2
L_back_p2:
    v_fma_f32 v40, v40, s39, -v56
    v_fma_f32 v41, v41, s39, -v56
    v_fma_f32 v42, v42, s39, -v56
    v_fma_f32 v43, v43, s39, -v56
    v_exp_f32 v40, v40
    v_exp_f32 v41, v41
    v_exp_f32 v42, v42
    v_exp_f32 v43, v43
    v_add_f32 v8, v40, v41
    v_add_f32 v9, v42, v43
    v_cvt_pk_bf16_f32 v40, v40, v40
    v_cvt_pk_bf16_f32 v41, v41, v41
    v_add_f32 v57, v57, v8
    v_cvt_pk_bf16_f32 v42, v42, v42
    v_cvt_pk_bf16_f32 v43, v43, v43
    v_add_f32 v57, v57, v9
    v_and_b32 v24, v40, v20
    v_and_b32 v25, v40, v21
    v_and_b32 v26, v40, v22
    v_and_b32 v27, v40, v23
    v_and_b32 v28, v41, v20
    v_and_b32 v29, v41, v21
    v_and_b32 v30, v41, v22
    v_and_b32 v31, v41, v23
    v_and_b32 v32, v42, v20
    v_and_b32 v33, v42, v21
    v_and_b32 v34, v42, v22
    v_and_b32 v35, v42, v23
    v_and_b32 v36, v43, v20
    v_and_b32 v37, v43, v21
    v_and_b32 v38, v43, v22
    v_and_b32 v39, v43, v23
    s_waitcnt vmcnt(8)
    s_cmp_eq_u32 s70, 2
    s_cbranch_scc1 L_wi_24
    s_waitcnt vmcnt(4)
    s_cmp_lg_u32 s70, 0
    s_cbranch_scc1 L_wi_24
    buffer_load_dwordx4 v[144:147], v16, s[20:23], s48 offen nt
    buffer_load_dwordx4 v[148:151], v16, s[20:23], s49 offen nt
    buffer_load_dwordx4 v[152:155], v16, s[20:23], s50 offen nt
    buffer_load_dwordx4 v[156:159], v16, s[20:23], s51 offen nt
L_wi_24:
    v_mfma_f32_16x16x32_bf16 v[64:67], v[160:163], v[24:27], v[64:67]
    v_mfma_f32_16x16x32_bf16 v[64:67], v[164:167], v[28:31], v[64:67]
    v_mfma_f32_16x16x32_bf16 v[64:67], v[168:171], v[32:35], v[64:67]
    v_mfma_f32_16x16x32_bf16 v[64:67], v[172:175], v[36:39], v[64:67]
    s_cmp_ge_u32 s46, s71
    s_cbranch_scc1 L_fast_exit
    s_waitcnt lgkmcnt(0)
    v_readfirstlane_b32 s47, v0
    s_cmp_lg_u32 s70, 1
    s_nop 3
    s_cbranch_scc1 L_cl_25
    buffer_load_dwordx4 v[144:147], v16, s[20:23], s48 offen nt
    buffer_load_dwordx4 v[148:151], v16, s[20:23], s49 offen nt
    buffer_load_dwordx4 v[152:155], v16, s[20:23], s50 offen nt
    buffer_load_dwordx4 v[156:159], v16, s[20:23], s51 offen nt
L_cl_25:
    s_mov_b32 s45, s46
    s_mov_b32 s46, s24
    s_mov_b32 s24, s47
    s_mov_b32 s70, s72
    s_and_b32 s48, s24, 0xfff
    s_lshl_b32 s48, s48, 16
    s_and_b32 s22, s24, 0x1f000
    s_add_u32 s22, s22, s48
    s_add_u32 s48, s48, s38
    s_add_u32 s50, s48, 32768
    s_add_u32 s49, s48, s69
    s_add_u32 s51, s50, s69
    s_branch L_vp_0
L_fast_exit:
    s_mov_b32 exec_lo, 0x01010101
    s_mov_b32 exec_hi, 0x01010101
    ds_write_b64 v62, v[56:57] offset:1024
    s_mov_b64 exec, -1
    s_nop 3
    ds_write_b128 v61, v[64:67]
    s_waitcnt lgkmcnt(0)
    s_barrier
    s_endpgm
L_rr_vp_0:
    ds_read_b32 v19, v11 offset:8448
    ds_read_b128 v[40:43], v10 offset:0
    s_branch L_rs_vp_0
L_rare_p0:
    v_mov_b32 v12, v8
    s_nop 1
    v_permlane32_swap_b32 v8, v12
    v_max_f32 v8, v8, v12
    v_mov_b32 v12, v8
    s_nop 1
    v_permlane16_swap_b32 v8, v12
    v_max_f32 v8, v8, v12
    v_mul_f32 v8, s39, v8
    v_max_f32 v8, v8, v56
    v_sub_f32 v12, v56, v8
    v_mov_b32 v56, v8
    v_exp_f32 v12, v12
    s_nop 0
    v_mul_f32 v57, v57, v12
    v_mul_f32 v64, v12, v64
    v_mul_f32 v65, v12, v65
    v_mul_f32 v66, v12, v66
    v_mul_f32 v67, v12, v67
    s_nop 0
    s_branch L_back_p0
L_rr_vp_1:
    ds_read_b32 v19, v11 offset:8448
    ds_read_b128 v[40:43], v10 offset:0
    s_branch L_rs_vp_1
L_rare_p1:
    v_mov_b32 v12, v8
    s_nop 1
    v_permlane32_swap_b32 v8, v12
    v_max_f32 v8, v8, v12
    v_mov_b32 v12, v8
    s_nop 1
    v_permlane16_swap_b32 v8, v12
    v_max_f32 v8, v8, v12
    v_mul_f32 v8, s39, v8
    v_max_f32 v8, v8, v56
    v_sub_f32 v12, v56, v8
    v_mov_b32 v56, v8
    v_exp_f32 v12, v12
    s_nop 0
    v_mul_f32 v57, v57, v12
    v_mul_f32 v64, v12, v64
    v_mul_f32 v65, v12, v65
    v_mul_f32 v66, v12, v66
    v_mul_f32 v67, v12, v67
    s_nop 0
    s_branch L_back_p1
L_rr_vp_2:
    ds_read_b32 v19, v11 offset:8448
    ds_read_b128 v[40:43], v10 offset:0
    s_branch L_rs_vp_2
L_rare_p2:
    v_mov_b32 v12, v8
    s_nop 1
    v_permlane32_swap_b32 v8, v12
    v_max_f32 v8, v8, v12
    v_mov_b32 v12, v8
    s_nop 1
    v_permlane16_swap_b32 v8, v12
    v_max_f32 v8, v8, v12
    v_mul_f32 v8, s39, v8
    v_max_f32 v8, v8, v56
    v_sub_f32 v12, v56, v8
    v_mov_b32 v56, v8
    v_exp_f32 v12, v12
    s_nop 0
    v_mul_f32 v57, v57, v12
    v_mul_f32 v64, v12, v64
    v_mul_f32 v65, v12, v65
    v_mul_f32 v66, v12, v66
    v_mul_f32 v67, v12, v67
    s_nop 0
    s_branch L_back_p2
L_switch_2:
    s_cmp_eq_u32 s70, 2
    s_cbranch_scc1 L_cl_26
    buffer_load_dwordx4 v[144:147], v16, s[20:23], s48 offen nt
    buffer_load_dwordx4 v[148:151], v16, s[20:23], s49 offen nt
    buffer_load_dwordx4 v[152:155], v16, s[20:23], s50 offen nt
    buffer_load_dwordx4 v[156:159], v16, s[20:23], s51 offen nt
L_cl_26:
    s_mov_b32 s43, 2
    s_branch L_switch
L_switch_1:
    s_cmp_eq_u32 s70, 2
    s_cbranch_scc1 L_cl_27
    buffer_load_dwordx4 v[128:131], v16, s[20:23], s48 offen nt
    buffer_load_dwordx4 v[132:135], v16, s[20:23], s49 offen nt
    buffer_load_dwordx4 v[136:139], v16, s[20:23], s50 offen nt
    buffer_load_dwordx4 v[140:143], v16, s[20:23], s51 offen nt
L_cl_27:
    s_mov_b32 s43, 1
    s_branch L_switch
L_switch_0:
    s_cmp_eq_u32 s70, 2
    s_cbranch_scc1 L_cl_28
    buffer_load_dwordx4 v[160:163], v16, s[20:23], s48 offen nt
    buffer_load_dwordx4 v[164:167], v16, s[20:23], s49 offen nt
    buffer_load_dwordx4 v[168:171], v16, s[20:23], s50 offen nt
    buffer_load_dwordx4 v[172:175], v16, s[20:23], s51 offen nt
L_cl_28:
    s_mov_b32 s43, 0
L_switch:
    s_mov_b32 s70, 2
    s_cmp_lg_u32 s53, 0
    s_cbranch_scc1 L_sy_29
L_sy_30:
    v_mov_b32 v14, 8192
    ds_read_b32 v14, v14
    s_mov_b32 s53, 1
    s_waitcnt lgkmcnt(0)
    v_readfirstlane_b32 s41, v14
    s_nop 0
    s_cmp_eq_u32 s41, 0
    s_nop 1
    s_cbranch_scc1 L_sy_30
    s_bfe_u32 s40, s41, 655378
    s_bitcmp0_b32 s41, 31
    s_cbranch_scc1 L_restart
L_sy_29:
    s_lshr_b32 s54, s45, 26
    s_cmp_ge_u32 s54, 32
    s_cbranch_scc1 L_sw_v
    s_mov_b32 s42, s54
    v_and_b32 v9, 0x70, v2
    s_cmp_eq_u32 s42, 0
    s_cbranch_scc1 L_sw_ks
    s_sub_u32 s54, s42, 2
    s_and_b32 s54, s54, 15
    s_cmp_eq_u32 s42, 17
    s_cselect_b32 s54, s37, s54
    s_lshl_b32 s54, s54, 9
    v_bfe_u32 v8, v1, 3, 1
    v_lshlrev_b32 v8, 8, v8
    v_add3_u32 v8, v8, v9, s54
    ds_read_b128 v[64:67], v8 offset:0
    ds_read_b128 v[68:71], v8 offset:128
    s_waitcnt lgkmcnt(0)
    s_cmp_eq_u32 s43, 0
    s_cbranch_scc1 L_kp_0
    s_cmp_eq_u32 s43, 1
    s_cbranch_scc1 L_kp_1
    s_branch L_kp_2
L_sw_ks:
    v_bfe_u32 v8, v1, 1, 3
    v_lshl_add_u32 v8, v8, 8, v9
    ds_read_b128 v[64:67], v8 offset:0
    ds_read_b128 v[68:71], v8 offset:128
    ds_read_b128 v[72:75], v8 offset:2048
    ds_read_b128 v[76:79], v8 offset:2176
    ds_read_b128 v[80:83], v8 offset:4096
    ds_read_b128 v[84:87], v8 offset:4224
    ds_read_b128 v[88:91], v8 offset:6144
    ds_read_b128 v[92:95], v8 offset:6272
    s_waitcnt lgkmcnt(0)
    s_cmp_eq_u32 s43, 0
    s_cbranch_scc1 L_ks_0
    s_cmp_eq_u32 s43, 1
    s_cbranch_scc1 L_ks_1
    s_branch L_ks_2
L_sw_v:
    s_cmp_lg_u32 s27, 0
    s_cbranch_scc1 L_flush
    s_mov_b32 s27, 1
L_v_init:
    s_ff1_i32_b32 s42, s41
    s_add_u32 s42, s42, 32
    s_cmp_eq_u32 s42, 49
    s_cselect_b32 s71, 0xfc000000, -1
    s_mul_i32 s54, s3, 1088
    s_add_u32 s54, s54, 25456
    v_lshl_add_u32 v61, v1, 4, s54
    v_add_u32 v62, s54, v1
    v_mov_b32 v56, 0xf149f2ca
    v_mov_b32 v57, 0
    v_mov_b32 v64, 0
    v_mov_b32 v65, 0
    v_mov_b32 v66, 0
    v_mov_b32 v67, 0
    s_cmp_eq_u32 s42, 32
    s_cbranch_scc1 L_vs_init
    s_cmp_eq_u32 s43, 0
    s_cbranch_scc1 L_vp_0
    s_cmp_eq_u32 s43, 1
    s_cbranch_scc1 L_vp_1
    s_branch L_vp_2
L_flush:
    s_cmp_eq_u32 s42, 32
    s_cbranch_scc1 L_flush_sh
    s_and_b32 s54, s26, 3
    s_cmp_eq_u32 s42, 49
    s_cselect_b32 s54, 4, s54
    s_cbranch_scc1 L_fl_go
    s_cmp_lt_u32 s26, 4
    s_cbranch_scc1 L_fl_go
    s_sub_u32 s56, s26, 3
L_fl_wait:
    ds_read_b32 v8, v6 offset:4
    s_waitcnt lgkmcnt(0)
    v_readfirstlane_b32 s55, v8
    s_nop 0
    s_cmp_lt_u32 s55, s56
    s_nop 1
    s_cbranch_scc1 L_fl_wait
L_fl_go:
    s_mul_i32 s54, s54, 3
    s_add_u32 s54, s54, s3
    s_mul_i32 s54, s54, 1088
    s_add_u32 s54, s54, 12400
    v_lshl_add_u32 v8, v1, 4, s54
    ds_write_b128 v8, v[64:67]
    v_add_u32 v8, s54, v1
    s_mov_b32 exec_lo, 0x01010101
    s_mov_b32 exec_hi, 0x01010101
    ds_write_b64 v8, v[56:57] offset:1024
    s_mov_b64 exec, -1
    s_cmp_eq_u32 s42, 49
    s_cbranch_scc1 L_c_final
    s_add_u32 s26, s26, 1
L_seg_done:
    s_sub_u32 s42, s42, 32
    s_lshl_b32 s54, s42, 2
    v_mov_b32 v8, s54
    s_waitcnt lgkmcnt(0)
    s_mov_b64 exec, 1
    ds_add_u32 v8, v7 offset:8320
    s_mov_b64 exec, -1
    s_bitset0_b32 s41, s42
    s_branch L_v_init
L_c_final:
    s_waitcnt lgkmcnt(0)
    s_barrier
    s_endpgm
L_ks_0:
    s_lshr_b32 s54, s45, 26
    s_cmp_lg_u32 s54, s42
    s_cbranch_scc1 L_switch_0
    s_bfe_u32 s57, s45, 589841
    s_cmp_lt_u32 s52, 12
    s_cbranch_scc1 L_g_31
    s_cmp_lg_u32 s53, 0
    s_cbranch_scc1 L_sy_32
L_sy_33:
    v_mov_b32 v14, 8192
    ds_read_b32 v14, v14
    s_mov_b32 s53, 1
    s_waitcnt lgkmcnt(0)
    v_readfirstlane_b32 s41, v14
    s_nop 0
    s_cmp_eq_u32 s41, 0
    s_nop 1
    s_cbranch_scc1 L_sy_33
    s_bfe_u32 s40, s41, 655378
    s_bitcmp0_b32 s41, 31
    s_cbranch_scc1 L_restart
L_sy_32:
    s_mov_b64 exec, 1
    ds_add_rtn_u32 v0, v6, v7
    s_mov_b64 exec, -1
L_g_31:
    s_waitcnt vmcnt(8)
    s_cmp_eq_u32 s70, 2
    s_cbranch_scc1 L_wi_34
    s_waitcnt vmcnt(4)
    buffer_load_dwordx4 v[160:163], v16, s[20:23], s48 offen nt
    buffer_load_dwordx4 v[164:167], v16, s[20:23], s49 offen nt
    buffer_load_dwordx4 v[168:171], v16, s[20:23], s50 offen nt
    buffer_load_dwordx4 v[172:175], v16, s[20:23], s51 offen nt
L_wi_34:
    v_mfma_f32_16x16x32_bf16 v[24:27], v[128:131], v[64:67], 0
    v_mfma_f32_16x16x32_bf16 v[28:31], v[136:139], v[64:67], 0
    v_mfma_f32_16x16x32_bf16 v[24:27], v[132:135], v[68:71], v[24:27]
    v_mfma_f32_16x16x32_bf16 v[28:31], v[140:143], v[68:71], v[28:31]
    v_mfma_f32_16x16x32_bf16 v[32:35], v[128:131], v[72:75], 0
    v_mfma_f32_16x16x32_bf16 v[36:39], v[136:139], v[72:75], 0
    v_mfma_f32_16x16x32_bf16 v[32:35], v[132:135], v[76:79], v[32:35]
    v_mfma_f32_16x16x32_bf16 v[36:39], v[140:143], v[76:79], v[36:39]
    s_lshl_b32 s56, s57, 11
    v_add_u32 v8, s56, v18
    s_waitcnt lgkmcnt(0)
    v_min_u32 v0, s40, v0
    v_lshlrev_b32 v0, 2, v0
    ds_read_b32 v0, v0 offset:10240
    v_add_f32_dpp v40, v25, v24 quad_perm:[1,1,3,3] row_mask:0xf bank_mask:0xf
    v_add_f32_dpp v41, v27, v26 quad_perm:[1,1,3,3] row_mask:0xf bank_mask:0xf
    v_add_f32_dpp v42, v29, v28 quad_perm:[1,1,3,3] row_mask:0xf bank_mask:0xf
    v_add_f32_dpp v43, v31, v30 quad_perm:[1,1,3,3] row_mask:0xf bank_mask:0xf
    v_mfma_f32_16x16x32_bf16 v[24:27], v[128:131], v[80:83], 0
    v_mfma_f32_16x16x32_bf16 v[28:31], v[136:139], v[80:83], 0
    v_mfma_f32_16x16x32_bf16 v[24:27], v[132:135], v[84:87], v[24:27]
    v_mfma_f32_16x16x32_bf16 v[28:31], v[140:143], v[84:87], v[28:31]
    v_add_f32_dpp v44, v33, v32 quad_perm:[1,1,3,3] row_mask:0xf bank_mask:0xf
    v_add_f32_dpp v45, v35, v34 quad_perm:[1,1,3,3] row_mask:0xf bank_mask:0xf
    v_add_f32_dpp v46, v37, v36 quad_perm:[1,1,3,3] row_mask:0xf bank_mask:0xf
    v_add_f32_dpp v47, v39, v38 quad_perm:[1,1,3,3] row_mask:0xf bank_mask:0xf
    v_mfma_f32_16x16x32_bf16 v[32:35], v[128:131], v[88:91], 0
    v_mfma_f32_16x16x32_bf16 v[36:39], v[136:139], v[88:91], 0
    v_mfma_f32_16x16x32_bf16 v[32:35], v[132:135], v[92:95], v[32:35]
    v_mfma_f32_16x16x32_bf16 v[36:39], v[140:143], v[92:95], v[36:39]
    s_waitcnt lgkmcnt(0)
    v_readfirstlane_b32 s47, v0
    s_cmp_lt_u32 s52, 12
    s_cselect_b32 s47, s68, s47
    s_addc_u32 s52, s52, 0
    s_add_u32 s68, s68, 393219
    v_add_f32_dpp v48, v25, v24 quad_perm:[1,1,3,3] row_mask:0xf bank_mask:0xf
    v_add_f32_dpp v49, v27, v26 quad_perm:[1,1,3,3] row_mask:0xf bank_mask:0xf
    v_add_f32_dpp v50, v29, v28 quad_perm:[1,1,3,3] row_mask:0xf bank_mask:0xf
    v_add_f32_dpp v51, v31, v30 quad_perm:[1,1,3,3] row_mask:0xf bank_mask:0xf
    v_add_f32_dpp v52, v33, v32 quad_perm:[1,1,3,3] row_mask:0xf bank_mask:0xf
    v_add_f32_dpp v53, v35, v34 quad_perm:[1,1,3,3] row_mask:0xf bank_mask:0xf
    v_add_f32_dpp v54, v37, v36 quad_perm:[1,1,3,3] row_mask:0xf bank_mask:0xf
    v_add_f32_dpp v55, v39, v38 quad_perm:[1,1,3,3] row_mask:0xf bank_mask:0xf
    s_mov_b32 exec_lo, 0x55555555
    s_mov_b32 exec_hi, 0x55555555
    ds_write_b128 v8, v[40:43] offset:0
    ds_write_b128 v8, v[44:47] offset:512
    ds_write_b128 v8, v[48:51] offset:1024
    ds_write_b128 v8, v[52:55] offset:1536
    s_lshl_b32 s55, s57, 2
    v_mov_b32 v9, s55
    v_mov_b32 v10, s25
    s_mov_b64 exec, 1
    ds_write_b32 v9, v10 offset:8448
    s_mov_b64 exec, -1
    s_mov_b32 s45, s46
    s_mov_b32 s46, s24
    s_mov_b32 s24, s47
    s_mov_b32 s70, s72
    s_bitcmp1_b32 s24, 31
    s_cbranch_scc1 L_ph_35
L_ph_36:
    s_and_b32 s48, s24, 0xfff
    s_lshl_b32 s48, s48, 16
    s_and_b32 s22, s24, 0x1f000
    s_add_u32 s22, s22, s48
    s_add_u32 s48, s48, s38
    s_add_u32 s50, s48, 32768
    s_add_u32 s49, s48, s69
    s_add_u32 s51, s50, s69
L_ks_1:
    s_lshr_b32 s54, s45, 26
    s_cmp_lg_u32 s54, s42
    s_cbranch_scc1 L_switch_1
    s_bfe_u32 s57, s45, 589841
    s_cmp_lt_u32 s52, 12
    s_cbranch_scc1 L_g_37
    s_cmp_lg_u32 s53, 0
    s_cbranch_scc1 L_sy_38
L_sy_39:
    v_mov_b32 v14, 8192
    ds_read_b32 v14, v14
    s_mov_b32 s53, 1
    s_waitcnt lgkmcnt(0)
    v_readfirstlane_b32 s41, v14
    s_nop 0
    s_cmp_eq_u32 s41, 0
    s_nop 1
    s_cbranch_scc1 L_sy_39
    s_bfe_u32 s40, s41, 655378
    s_bitcmp0_b32 s41, 31
    s_cbranch_scc1 L_restart
L_sy_38:
    s_mov_b64 exec, 1
    ds_add_rtn_u32 v0, v6, v7
    s_mov_b64 exec, -1
L_g_37:
    s_waitcnt vmcnt(8)
    s_cmp_eq_u32 s70, 2
    s_cbranch_scc1 L_wi_40
    s_waitcnt vmcnt(4)
    buffer_load_dwordx4 v[128:131], v16, s[20:23], s48 offen nt
    buffer_load_dwordx4 v[132:135], v16, s[20:23], s49 offen nt
    buffer_load_dwordx4 v[136:139], v16, s[20:23], s50 offen nt
    buffer_load_dwordx4 v[140:143], v16, s[20:23], s51 offen nt
L_wi_40:
    v_mfma_f32_16x16x32_bf16 v[24:27], v[144:147], v[64:67], 0
    v_mfma_f32_16x16x32_bf16 v[28:31], v[152:155], v[64:67], 0
    v_mfma_f32_16x16x32_bf16 v[24:27], v[148:151], v[68:71], v[24:27]
    v_mfma_f32_16x16x32_bf16 v[28:31], v[156:159], v[68:71], v[28:31]
    v_mfma_f32_16x16x32_bf16 v[32:35], v[144:147], v[72:75], 0
    v_mfma_f32_16x16x32_bf16 v[36:39], v[152:155], v[72:75], 0
    v_mfma_f32_16x16x32_bf16 v[32:35], v[148:151], v[76:79], v[32:35]
    v_mfma_f32_16x16x32_bf16 v[36:39], v[156:159], v[76:79], v[36:39]
    s_lshl_b32 s56, s57, 11
    v_add_u32 v8, s56, v18
    s_waitcnt lgkmcnt(0)
    v_min_u32 v0, s40, v0
    v_lshlrev_b32 v0, 2, v0
    ds_read_b32 v0, v0 offset:10240
    v_add_f32_dpp v40, v25, v24 quad_perm:[1,1,3,3] row_mask:0xf bank_mask:0xf
    v_add_f32_dpp v41, v27, v26 quad_perm:[1,1,3,3] row_mask:0xf bank_mask:0xf
    v_add_f32_dpp v42, v29, v28 quad_perm:[1,1,3,3] row_mask:0xf bank_mask:0xf
    v_add_f32_dpp v43, v31, v30 quad_perm:[1,1,3,3] row_mask:0xf bank_mask:0xf
    v_mfma_f32_16x16x32_bf16 v[24:27], v[144:147], v[80:83], 0
    v_mfma_f32_16x16x32_bf16 v[28:31], v[152:155], v[80:83], 0
    v_mfma_f32_16x16x32_bf16 v[24:27], v[148:151], v[84:87], v[24:27]
    v_mfma_f32_16x16x32_bf16 v[28:31], v[156:159], v[84:87], v[28:31]
    v_add_f32_dpp v44, v33, v32 quad_perm:[1,1,3,3] row_mask:0xf bank_mask:0xf
    v_add_f32_dpp v45, v35, v34 quad_perm:[1,1,3,3] row_mask:0xf bank_mask:0xf
    v_add_f32_dpp v46, v37, v36 quad_perm:[1,1,3,3] row_mask:0xf bank_mask:0xf
    v_add_f32_dpp v47, v39, v38 quad_perm:[1,1,3,3] row_mask:0xf bank_mask:0xf
    v_mfma_f32_16x16x32_bf16 v[32:35], v[144:147], v[88:91], 0
    v_mfma_f32_16x16x32_bf16 v[36:39], v[152:155], v[88:91], 0
    v_mfma_f32_16x16x32_bf16 v[32:35], v[148:151], v[92:95], v[32:35]
    v_mfma_f32_16x16x32_bf16 v[36:39], v[156:159], v[92:95], v[36:39]
    s_waitcnt lgkmcnt(0)
    v_readfirstlane_b32 s47, v0
    s_cmp_lt_u32 s52, 12
    s_cselect_b32 s47, s68, s47
    s_addc_u32 s52, s52, 0
    s_add_u32 s68, s68, 393219
    v_add_f32_dpp v48, v25, v24 quad_perm:[1,1,3,3] row_mask:0xf bank_mask:0xf
    v_add_f32_dpp v49, v27, v26 quad_perm:[1,1,3,3] row_mask:0xf bank_mask:0xf
    v_add_f32_dpp v50, v29, v28 quad_perm:[1,1,3,3] row_mask:0xf bank_mask:0xf
    v_add_f32_dpp v51, v31, v30 quad_perm:[1,1,3,3] row_mask:0xf bank_mask:0xf
    v_add_f32_dpp v52, v33, v32 quad_perm:[1,1,3,3] row_mask:0xf bank_mask:0xf
    v_add_f32_dpp v53, v35, v34 quad_perm:[1,1,3,3] row_mask:0xf bank_mask:0xf
    v_add_f32_dpp v54, v37, v36 quad_perm:[1,1,3,3] row_mask:0xf bank_mask:0xf
    v_add_f32_dpp v55, v39, v38 quad_perm:[1,1,3,3] row_mask:0xf bank_mask:0xf
    s_mov_b32 exec_lo, 0x55555555
    s_mov_b32 exec_hi, 0x55555555
    ds_write_b128 v8, v[40:43] offset:0
    ds_write_b128 v8, v[44:47] offset:512
    ds_write_b128 v8, v[48:51] offset:1024
    ds_write_b128 v8, v[52:55] offset:1536
    s_lshl_b32 s55, s57, 2
    v_mov_b32 v9, s55
    v_mov_b32 v10, s25
    s_mov_b64 exec, 1
    ds_write_b32 v9, v10 offset:8448
    s_mov_b64 exec, -1
    s_mov_b32 s45, s46
    s_mov_b32 s46, s24
    s_mov_b32 s24, s47
    s_mov_b32 s70, s72
    s_bitcmp1_b32 s24, 31
    s_cbranch_scc1 L_ph_41
L_ph_42:
    s_and_b32 s48, s24, 0xfff
    s_lshl_b32 s48, s48, 16
    s_and_b32 s22, s24, 0x1f000
    s_add_u32 s22, s22, s48
    s_add_u32 s48, s48, s38
    s_add_u32 s50, s48, 32768
    s_add_u32 s49, s48, s69
    s_add_u32 s51, s50, s69
L_ks_2:
    s_lshr_b32 s54, s45, 26
    s_cmp_lg_u32 s54, s42
    s_cbranch_scc1 L_switch_2
    s_bfe_u32 s57, s45, 589841
    s_cmp_lt_u32 s52, 12
    s_cbranch_scc1 L_g_43
    s_cmp_lg_u32 s53, 0
    s_cbranch_scc1 L_sy_44
L_sy_45:
    v_mov_b32 v14, 8192
    ds_read_b32 v14, v14
    s_mov_b32 s53, 1
    s_waitcnt lgkmcnt(0)
    v_readfirstlane_b32 s41, v14
    s_nop 0
    s_cmp_eq_u32 s41, 0
    s_nop 1
    s_cbranch_scc1 L_sy_45
    s_bfe_u32 s40, s41, 655378
    s_bitcmp0_b32 s41, 31
    s_cbranch_scc1 L_restart
L_sy_44:
    s_mov_b64 exec, 1
    ds_add_rtn_u32 v0, v6, v7
    s_mov_b64 exec, -1
L_g_43:
    s_waitcnt vmcnt(8)
    s_cmp_eq_u32 s70, 2
    s_cbranch_scc1 L_wi_46
    s_waitcnt vmcnt(4)
    buffer_load_dwordx4 v[144:147], v16, s[20:23], s48 offen nt
    buffer_load_dwordx4 v[148:151], v16, s[20:23], s49 offen nt
    buffer_load_dwordx4 v[152:155], v16, s[20:23], s50 offen nt
    buffer_load_dwordx4 v[156:159], v16, s[20:23], s51 offen nt
L_wi_46:
    v_mfma_f32_16x16x32_bf16 v[24:27], v[160:163], v[64:67], 0
    v_mfma_f32_16x16x32_bf16 v[28:31], v[168:171], v[64:67], 0
    v_mfma_f32_16x16x32_bf16 v[24:27], v[164:167], v[68:71], v[24:27]
    v_mfma_f32_16x16x32_bf16 v[28:31], v[172:175], v[68:71], v[28:31]
    v_mfma_f32_16x16x32_bf16 v[32:35], v[160:163], v[72:75], 0
    v_mfma_f32_16x16x32_bf16 v[36:39], v[168:171], v[72:75], 0
    v_mfma_f32_16x16x32_bf16 v[32:35], v[164:167], v[76:79], v[32:35]
    v_mfma_f32_16x16x32_bf16 v[36:39], v[172:175], v[76:79], v[36:39]
    s_lshl_b32 s56, s57, 11
    v_add_u32 v8, s56, v18
    s_waitcnt lgkmcnt(0)
    v_min_u32 v0, s40, v0
    v_lshlrev_b32 v0, 2, v0
    ds_read_b32 v0, v0 offset:10240
    v_add_f32_dpp v40, v25, v24 quad_perm:[1,1,3,3] row_mask:0xf bank_mask:0xf
    v_add_f32_dpp v41, v27, v26 quad_perm:[1,1,3,3] row_mask:0xf bank_mask:0xf
    v_add_f32_dpp v42, v29, v28 quad_perm:[1,1,3,3] row_mask:0xf bank_mask:0xf
    v_add_f32_dpp v43, v31, v30 quad_perm:[1,1,3,3] row_mask:0xf bank_mask:0xf
    v_mfma_f32_16x16x32_bf16 v[24:27], v[160:163], v[80:83], 0
    v_mfma_f32_16x16x32_bf16 v[28:31], v[168:171], v[80:83], 0
    v_mfma_f32_16x16x32_bf16 v[24:27], v[164:167], v[84:87], v[24:27]
    v_mfma_f32_16x16x32_bf16 v[28:31], v[172:175], v[84:87], v[28:31]
    v_add_f32_dpp v44, v33, v32 quad_perm:[1,1,3,3] row_mask:0xf bank_mask:0xf
    v_add_f32_dpp v45, v35, v34 quad_perm:[1,1,3,3] row_mask:0xf bank_mask:0xf
    v_add_f32_dpp v46, v37, v36 quad_perm:[1,1,3,3] row_mask:0xf bank_mask:0xf
    v_add_f32_dpp v47, v39, v38 quad_perm:[1,1,3,3] row_mask:0xf bank_mask:0xf
    v_mfma_f32_16x16x32_bf16 v[32:35], v[160:163], v[88:91], 0
    v_mfma_f32_16x16x32_bf16 v[36:39], v[168:171], v[88:91], 0
    v_mfma_f32_16x16x32_bf16 v[32:35], v[164:167], v[92:95], v[32:35]
    v_mfma_f32_16x16x32_bf16 v[36:39], v[172:175], v[92:95], v[36:39]
    s_waitcnt lgkmcnt(0)
    v_readfirstlane_b32 s47, v0
    s_cmp_lt_u32 s52, 12
    s_cselect_b32 s47, s68, s47
    s_addc_u32 s52, s52, 0
    s_add_u32 s68, s68, 393219
    v_add_f32_dpp v48, v25, v24 quad_perm:[1,1,3,3] row_mask:0xf bank_mask:0xf
    v_add_f32_dpp v49, v27, v26 quad_perm:[1,1,3,3] row_mask:0xf bank_mask:0xf
    v_add_f32_dpp v50, v29, v28 quad_perm:[1,1,3,3] row_mask:0xf bank_mask:0xf
    v_add_f32_dpp v51, v31, v30 quad_perm:[1,1,3,3] row_mask:0xf bank_mask:0xf
    v_add_f32_dpp v52, v33, v32 quad_perm:[1,1,3,3] row_mask:0xf bank_mask:0xf
    v_add_f32_dpp v53, v35, v34 quad_perm:[1,1,3,3] row_mask:0xf bank_mask:0xf
    v_add_f32_dpp v54, v37, v36 quad_perm:[1,1,3,3] row_mask:0xf bank_mask:0xf
    v_add_f32_dpp v55, v39, v38 quad_perm:[1,1,3,3] row_mask:0xf bank_mask:0xf
    s_mov_b32 exec_lo, 0x55555555
    s_mov_b32 exec_hi, 0x55555555
    ds_write_b128 v8, v[40:43] offset:0
    ds_write_b128 v8, v[44:47] offset:512
    ds_write_b128 v8, v[48:51] offset:1024
    ds_write_b128 v8, v[52:55] offset:1536
    s_lshl_b32 s55, s57, 2
    v_mov_b32 v9, s55
    v_mov_b32 v10, s25
    s_mov_b64 exec, 1
    ds_write_b32 v9, v10 offset:8448
    s_mov_b64 exec, -1
    s_mov_b32 s45, s46
    s_mov_b32 s46, s24
    s_mov_b32 s24, s47
    s_mov_b32 s70, s72
    s_bitcmp1_b32 s24, 31
    s_cbranch_scc1 L_ph_47
L_ph_48:
    s_and_b32 s48, s24, 0xfff
    s_lshl_b32 s48, s48, 16
    s_and_b32 s22, s24, 0x1f000
    s_add_u32 s22, s22, s48
    s_add_u32 s48, s48, s38
    s_add_u32 s50, s48, 32768
    s_add_u32 s49, s48, s69
    s_add_u32 s51, s50, s69
    s_branch L_ks_0
L_vs_init:
    v_mov_b32 v58, 0xf149f2ca
    v_mov_b32 v59, 0
    v_mov_b32 v68, 0
    v_mov_b32 v69, 0
    v_mov_b32 v70, 0
    v_mov_b32 v71, 0
    v_mov_b32 v72, 0
    v_mov_b32 v73, 0
    v_mov_b32 v74, 0
    v_mov_b32 v75, 0
    v_mov_b32 v76, 0
    v_mov_b32 v77, 0
    v_mov_b32 v78, 0
    v_mov_b32 v79, 0
    v_mov_b32 v80, 0
    v_mov_b32 v81, 0
    v_mov_b32 v82, 0
    v_mov_b32 v83, 0
    v_mov_b32 v84, 0
    v_mov_b32 v85, 0
    v_mov_b32 v86, 0
    v_mov_b32 v87, 0
    v_mov_b32 v88, 0
    v_mov_b32 v89, 0
    v_mov_b32 v90, 0
    v_mov_b32 v91, 0
    v_mov_b32 v92, 0
    v_mov_b32 v93, 0
    v_mov_b32 v94, 0
    v_mov_b32 v95, 0
    v_mov_b32 v96, 0
    v_mov_b32 v97, 0
    v_mov_b32 v98, 0
    v_mov_b32 v99, 0
    v_mov_b32 v100, 0
    v_mov_b32 v101, 0
    v_mov_b32 v102, 0
    v_mov_b32 v103, 0
    v_mov_b32 v104, 0
    v_mov_b32 v105, 0
    v_mov_b32 v106, 0
    v_mov_b32 v107, 0
    v_mov_b32 v108, 0
    v_mov_b32 v109, 0
    v_mov_b32 v110, 0
    v_mov_b32 v111, 0
    v_mov_b32 v112, 0
    v_mov_b32 v113, 0
    v_mov_b32 v114, 0
    v_mov_b32 v115, 0
    v_mov_b32 v116, 0
    v_mov_b32 v117, 0
    v_mov_b32 v118, 0
    v_mov_b32 v119, 0
    v_mov_b32 v120, 0
    v_mov_b32 v121, 0
    v_mov_b32 v122, 0
    v_mov_b32 v123, 0
    v_mov_b32 v124, 0
    v_mov_b32 v125, 0
    v_mov_b32 v126, 0
    v_mov_b32 v127, 0
    s_cmp_eq_u32 s43, 0
    s_cbranch_scc1 L_vs_0
    s_cmp_eq_u32 s43, 1
    s_cbranch_scc1 L_vs_1
    s_branch L_vs_2
L_vs_0:
    s_lshr_b32 s54, s45, 26
    s_cmp_lg_u32 s54, s42
    s_cbranch_scc1 L_switch_0
    s_bfe_u32 s57, s45, 589841
    s_mov_b64 exec, 1
    ds_add_rtn_u32 v0, v6, v7
    s_mov_b64 exec, -1
    s_lshl_b32 s55, s57, 2
    s_lshl_b32 s56, s57, 11
    v_mov_b32 v11, s55
    v_add_u32 v10, s56, v60
    ds_read_b32 v19, v11 offset:8448
    ds_read_b128 v[40:43], v10 offset:0
    ds_read_b128 v[44:47], v10 offset:512
    s_waitcnt vmcnt(8)
    s_cmp_eq_u32 s70, 2
    s_cbranch_scc1 L_wi_49
    s_waitcnt vmcnt(4)
    buffer_load_dwordx4 v[160:163], v16, s[20:23], s48 offen nt
    buffer_load_dwordx4 v[164:167], v16, s[20:23], s49 offen nt
    buffer_load_dwordx4 v[168:171], v16, s[20:23], s50 offen nt
    buffer_load_dwordx4 v[172:175], v16, s[20:23], s51 offen nt
L_wi_49:
    v_swap_b32 v129, v132
    v_swap_b32 v130, v136
    v_swap_b32 v131, v140
    v_swap_b32 v134, v137
    v_swap_b32 v135, v141
    v_swap_b32 v139, v142
    s_nop 1
L_rs_vs_0:
    s_waitcnt lgkmcnt(0)
    v_readfirstlane_b32 s55, v19
    s_nop 0
    s_cmp_lg_u32 s55, s25
    s_nop 1
    s_cbranch_scc1 L_rr_vs_0
    v_min_u32 v0, s40, v0
    v_lshlrev_b32 v0, 2, v0
    ds_read_b32 v0, v0 offset:10240
    v_max3_f32 v8, v40, v41, v42
    v_max3_f32 v9, v44, v45, v46
    v_max_f32 v8, v8, v43
    v_max_f32 v9, v9, v47
    v_fma_f32 v12, v8, s39, -v56
    v_fma_f32 v13, v9, s39, -v58
    v_max_f32 v12, v12, v13
    v_cmp_lt_f32 vcc, 0x40c00000, v12
    s_nop 0
    s_cmp_lg_u64 vcc, 0
    s_nop 1
    s_cbranch_scc1 L_rare_s0
L_back_s0:
    v_fma_f32 v40, v40, s39, -v56
    v_fma_f32 v41, v41, s39, -v56
    v_fma_f32 v42, v42, s39, -v56
    v_fma_f32 v43, v43, s39, -v56
    v_exp_f32 v40, v40
    v_exp_f32 v41, v41
    v_exp_f32 v42, v42
    v_exp_f32 v43, v43
    v_add_f32 v8, v40, v41
    v_add_f32 v9, v42, v43
    v_cvt_pk_bf16_f32 v40, v40, v40
    v_cvt_pk_bf16_f32 v41, v41, v41
    v_add_f32 v57, v57, v8
    v_cvt_pk_bf16_f32 v42, v42, v42
    v_cvt_pk_bf16_f32 v43, v43, v43
    v_add_f32 v57, v57, v9
    v_and_b32_dpp v24, v40, v5 quad_perm:[0,0,2,2] row_mask:0xf bank_mask:0xf
    v_and_b32_dpp v25, v41, v5 quad_perm:[0,0,2,2] row_mask:0xf bank_mask:0xf
    v_and_b32_dpp v26, v42, v5 quad_perm:[0,0,2,2] row_mask:0xf bank_mask:0xf
    v_and_b32_dpp v27, v43, v5 quad_perm:[0,0,2,2] row_mask:0xf bank_mask:0xf
    v_and_b32_dpp v28, v40, v5 quad_perm:[1,1,3,3] row_mask:0xf bank_mask:0xf
    v_and_b32_dpp v29, v41, v5 quad_perm:[1,1,3,3] row_mask:0xf bank_mask:0xf
    v_and_b32_dpp v30, v42, v5 quad_perm:[1,1,3,3] row_mask:0xf bank_mask:0xf
    v_and_b32_dpp v31, v43, v5 quad_perm:[1,1,3,3] row_mask:0xf bank_mask:0xf
    v_mfma_f32_16x16x32_bf16 v[64:67], v[128:131], v[24:27], v[64:67]
    v_mfma_f32_16x16x32_bf16 v[68:71], v[132:135], v[24:27], v[68:71]
    v_mfma_f32_16x16x32_bf16 v[72:75], v[136:139], v[24:27], v[72:75]
    v_mfma_f32_16x16x32_bf16 v[76:79], v[140:143], v[24:27], v[76:79]
    v_mfma_f32_16x16x32_bf16 v[96:99], v[128:131], v[28:31], v[96:99]
    v_mfma_f32_16x16x32_bf16 v[100:103], v[132:135], v[28:31], v[100:103]
    v_mfma_f32_16x16x32_bf16 v[104:107], v[136:139], v[28:31], v[104:107]
    v_mfma_f32_16x16x32_bf16 v[108:111], v[140:143], v[28:31], v[108:111]
    v_fma_f32 v44, v44, s39, -v58
    v_fma_f32 v45, v45, s39, -v58
    v_fma_f32 v46, v46, s39, -v58
    v_fma_f32 v47, v47, s39, -v58
    v_exp_f32 v44, v44
    v_exp_f32 v45, v45
    v_exp_f32 v46, v46
    v_exp_f32 v47, v47
    v_add_f32 v8, v44, v45
    v_add_f32 v9, v46, v47
    v_cvt_pk_bf16_f32 v44, v44, v44
    v_cvt_pk_bf16_f32 v45, v45, v45
    v_add_f32 v59, v59, v8
    v_cvt_pk_bf16_f32 v46, v46, v46
    v_cvt_pk_bf16_f32 v47, v47, v47
    v_add_f32 v59, v59, v9
    v_and_b32_dpp v32, v44, v5 quad_perm:[0,0,2,2] row_mask:0xf bank_mask:0xf
    v_and_b32_dpp v33, v45, v5 quad_perm:[0,0,2,2] row_mask:0xf bank_mask:0xf
    v_and_b32_dpp v34, v46, v5 quad_perm:[0,0,2,2] row_mask:0xf bank_mask:0xf
    v_and_b32_dpp v35, v47, v5 quad_perm:[0,0,2,2] row_mask:0xf bank_mask:0xf
    v_and_b32_dpp v36, v44, v5 quad_perm:[1,1,3,3] row_mask:0xf bank_mask:0xf
    v_and_b32_dpp v37, v45, v5 quad_perm:[1,1,3,3] row_mask:0xf bank_mask:0xf
    v_and_b32_dpp v38, v46, v5 quad_perm:[1,1,3,3] row_mask:0xf bank_mask:0xf
    v_and_b32_dpp v39, v47, v5 quad_perm:[1,1,3,3] row_mask:0xf bank_mask:0xf
    v_mfma_f32_16x16x32_bf16 v[80:83], v[128:131], v[32:35], v[80:83]
    v_mfma_f32_16x16x32_bf16 v[84:87], v[132:135], v[32:35], v[84:87]
    v_mfma_f32_16x16x32_bf16 v[88:91], v[136:139], v[32:35], v[88:91]
    v_mfma_f32_16x16x32_bf16 v[92:95], v[140:143], v[32:35], v[92:95]
    v_mfma_f32_16x16x32_bf16 v[112:115], v[128:131], v[36:39], v[112:115]
    v_mfma_f32_16x16x32_bf16 v[116:119], v[132:135], v[36:39], v[116:119]
    v_mfma_f32_16x16x32_bf16 v[120:123], v[136:139], v[36:39], v[120:123]
    v_mfma_f32_16x16x32_bf16 v[124:127], v[140:143], v[36:39], v[124:127]
    s_waitcnt lgkmcnt(0)
    v_readfirstlane_b32 s47, v0
    s_mov_b32 s45, s46
    s_mov_b32 s46, s24
    s_mov_b32 s24, s47
    s_mov_b32 s70, s72
    s_and_b32 s48, s24, 0xfff
    s_lshl_b32 s48, s48, 16
    s_and_b32 s22, s24, 0x1f000
    s_add_u32 s22, s22, s48
    s_add_u32 s48, s48, s38
    s_add_u32 s50, s48, 32768
    s_add_u32 s49, s48, s69
    s_add_u32 s51, s50, s69
L_vs_1:
    s_lshr_b32 s54, s45, 26
    s_cmp_lg_u32 s54, s42
    s_cbranch_scc1 L_switch_1
    s_bfe_u32 s57, s45, 589841
    s_mov_b64 exec, 1
    ds_add_rtn_u32 v0, v6, v7
    s_mov_b64 exec, -1
    s_lshl_b32 s55, s57, 2
    s_lshl_b32 s56, s57, 11
    v_mov_b32 v11, s55
    v_add_u32 v10, s56, v60
    ds_read_b32 v19, v11 offset:8448
    ds_read_b128 v[40:43], v10 offset:0
    ds_read_b128 v[44:47], v10 offset:512
    s_waitcnt vmcnt(8)
    s_cmp_eq_u32 s70, 2
    s_cbranch_scc1 L_wi_50
    s_waitcnt vmcnt(4)
    buffer_load_dwordx4 v[128:131], v16, s[20:23], s48 offen nt
    buffer_load_dwordx4 v[132:135], v16, s[20:23], s49 offen nt
    buffer_load_dwordx4 v[136:139], v16, s[20:23], s50 offen nt
    buffer_load_dwordx4 v[140:143], v16, s[20:23], s51 offen nt
L_wi_50:
    v_swap_b32 v145, v148
    v_swap_b32 v146, v152
    v_swap_b32 v147, v156
    v_swap_b32 v150, v153
    v_swap_b32 v151, v157
    v_swap_b32 v155, v158
    s_nop 1
L_rs_vs_1:
    s_waitcnt lgkmcnt(0)
    v_readfirstlane_b32 s55, v19
    s_nop 0
    s_cmp_lg_u32 s55, s25
    s_nop 1
    s_cbranch_scc1 L_rr_vs_1
    v_min_u32 v0, s40, v0
    v_lshlrev_b32 v0, 2, v0
    ds_read_b32 v0, v0 offset:10240
    v_max3_f32 v8, v40, v41, v42
    v_max3_f32 v9, v44, v45, v46
    v_max_f32 v8, v8, v43
    v_max_f32 v9, v9, v47
    v_fma_f32 v12, v8, s39, -v56
    v_fma_f32 v13, v9, s39, -v58
    v_max_f32 v12, v12, v13
    v_cmp_lt_f32 vcc, 0x40c00000, v12
    s_nop 0
    s_cmp_lg_u64 vcc, 0
    s_nop 1
    s_cbranch_scc1 L_rare_s1
L_back_s1:
    v_fma_f32 v40, v40, s39, -v56
    v_fma_f32 v41, v41, s39, -v56
    v_fma_f32 v42, v42, s39, -v56
    v_fma_f32 v43, v43, s39, -v56
    v_exp_f32 v40, v40
    v_exp_f32 v41, v41
    v_exp_f32 v42, v42
    v_exp_f32 v43, v43
    v_add_f32 v8, v40, v41
    v_add_f32 v9, v42, v43
    v_cvt_pk_bf16_f32 v40, v40, v40
    v_cvt_pk_bf16_f32 v41, v41, v41
    v_add_f32 v57, v57, v8
    v_cvt_pk_bf16_f32 v42, v42, v42
    v_cvt_pk_bf16_f32 v43, v43, v43
    v_add_f32 v57, v57, v9
    v_and_b32_dpp v24, v40, v5 quad_perm:[0,0,2,2] row_mask:0xf bank_mask:0xf
    v_and_b32_dpp v25, v41, v5 quad_perm:[0,0,2,2] row_mask:0xf bank_mask:0xf
    v_and_b32_dpp v26, v42, v5 quad_perm:[0,0,2,2] row_mask:0xf bank_mask:0xf
    v_and_b32_dpp v27, v43, v5 quad_perm:[0,0,2,2] row_mask:0xf bank_mask:0xf
    v_and_b32_dpp v28, v40, v5 quad_perm:[1,1,3,3] row_mask:0xf bank_mask:0xf
    v_and_b32_dpp v29, v41, v5 quad_perm:[1,1,3,3] row_mask:0xf bank_mask:0xf
    v_and_b32_dpp v30, v42, v5 quad_perm:[1,1,3,3] row_mask:0xf bank_mask:0xf
    v_and_b32_dpp v31, v43, v5 quad_perm:[1,1,3,3] row_mask:0xf bank_mask:0xf
    v_mfma_f32_16x16x32_bf16 v[64:67], v[144:147], v[24:27], v[64:67]
    v_mfma_f32_16x16x32_bf16 v[68:71], v[148:151], v[24:27], v[68:71]
    v_mfma_f32_16x16x32_bf16 v[72:75], v[152:155], v[24:27], v[72:75]
    v_mfma_f32_16x16x32_bf16 v[76:79], v[156:159], v[24:27], v[76:79]
    v_mfma_f32_16x16x32_bf16 v[96:99], v[144:147], v[28:31], v[96:99]
    v_mfma_f32_16x16x32_bf16 v[100:103], v[148:151], v[28:31], v[100:103]
    v_mfma_f32_16x16x32_bf16 v[104:107], v[152:155], v[28:31], v[104:107]
    v_mfma_f32_16x16x32_bf16 v[108:111], v[156:159], v[28:31], v[108:111]
    v_fma_f32 v44, v44, s39, -v58
    v_fma_f32 v45, v45, s39, -v58
    v_fma_f32 v46, v46, s39, -v58
    v_fma_f32 v47, v47, s39, -v58
    v_exp_f32 v44, v44
    v_exp_f32 v45, v45
    v_exp_f32 v46, v46
    v_exp_f32 v47, v47
    v_add_f32 v8, v44, v45
    v_add_f32 v9, v46, v47
    v_cvt_pk_bf16_f32 v44, v44, v44
    v_cvt_pk_bf16_f32 v45, v45, v45
    v_add_f32 v59, v59, v8
    v_cvt_pk_bf16_f32 v46, v46, v46
    v_cvt_pk_bf16_f32 v47, v47, v47
    v_add_f32 v59, v59, v9
    v_and_b32_dpp v32, v44, v5 quad_perm:[0,0,2,2] row_mask:0xf bank_mask:0xf
    v_and_b32_dpp v33, v45, v5 quad_perm:[0,0,2,2] row_mask:0xf bank_mask:0xf
    v_and_b32_dpp v34, v46, v5 quad_perm:[0,0,2,2] row_mask:0xf bank_mask:0xf
    v_and_b32_dpp v35, v47, v5 quad_perm:[0,0,2,2] row_mask:0xf bank_mask:0xf
    v_and_b32_dpp v36, v44, v5 quad_perm:[1,1,3,3] row_mask:0xf bank_mask:0xf
    v_and_b32_dpp v37, v45, v5 quad_perm:[1,1,3,3] row_mask:0xf bank_mask:0xf
    v_and_b32_dpp v38, v46, v5 quad_perm:[1,1,3,3] row_mask:0xf bank_mask:0xf
    v_and_b32_dpp v39, v47, v5 quad_perm:[1,1,3,3] row_mask:0xf bank_mask:0xf
    v_mfma_f32_16x16x32_bf16 v[80:83], v[144:147], v[32:35], v[80:83]
    v_mfma_f32_16x16x32_bf16 v[84:87], v[148:151], v[32:35], v[84:87]
    v_mfma_f32_16x16x32_bf16 v[88:91], v[152:155], v[32:35], v[88:91]
    v_mfma_f32_16x16x32_bf16 v[92:95], v[156:159], v[32:35], v[92:95]
    v_mfma_f32_16x16x32_bf16 v[112:115], v[144:147], v[36:39], v[112:115]
    v_mfma_f32_16x16x32_bf16 v[116:119], v[148:151], v[36:39], v[116:119]
    v_mfma_f32_16x16x32_bf16 v[120:123], v[152:155], v[36:39], v[120:123]
    v_mfma_f32_16x16x32_bf16 v[124:127], v[156:159], v[36:39], v[124:127]
    s_waitcnt lgkmcnt(0)
    v_readfirstlane_b32 s47, v0
    s_mov_b32 s45, s46
    s_mov_b32 s46, s24
    s_mov_b32 s24, s47
    s_mov_b32 s70, s72
    s_and_b32 s48, s24, 0xfff
    s_lshl_b32 s48, s48, 16
    s_and_b32 s22, s24, 0x1f000
    s_add_u32 s22, s22, s48
    s_add_u32 s48, s48, s38
    s_add_u32 s50, s48, 32768
    s_add_u32 s49, s48, s69
    s_add_u32 s51, s50, s69
L_vs_2:
    s_lshr_b32 s54, s45, 26
    s_cmp_lg_u32 s54, s42
    s_cbranch_scc1 L_switch_2
    s_bfe_u32 s57, s45, 589841
    s_mov_b64 exec, 1
    ds_add_rtn_u32 v0, v6, v7
    s_mov_b64 exec, -1
    s_lshl_b32 s55, s57, 2
    s_lshl_b32 s56, s57, 11
    v_mov_b32 v11, s55
    v_add_u32 v10, s56, v60
    ds_read_b32 v19, v11 offset:8448
    ds_read_b128 v[40:43], v10 offset:0
    ds_read_b128 v[44:47], v10 offset:512
    s_waitcnt vmcnt(8)
    s_cmp_eq_u32 s70, 2
    s_cbranch_scc1 L_wi_51
    s_waitcnt vmcnt(4)
    buffer_load_dwordx4 v[144:147], v16, s[20:23], s48 offen nt
    buffer_load_dwordx4 v[148:151], v16, s[20:23], s49 offen nt
    buffer_load_dwordx4 v[152:155], v16, s[20:23], s50 offen nt
    buffer_load_dwordx4 v[156:159], v16, s[20:23], s51 offen nt
L_wi_51:
    v_swap_b32 v161, v164
    v_swap_b32 v162, v168
    v_swap_b32 v163, v172
    v_swap_b32 v166, v169
    v_swap_b32 v167, v173
    v_swap_b32 v171, v174
    s_nop 1
L_rs_vs_2:
    s_waitcnt lgkmcnt(0)
    v_readfirstlane_b32 s55, v19
    s_nop 0
    s_cmp_lg_u32 s55, s25
    s_nop 1
    s_cbranch_scc1 L_rr_vs_2
    v_min_u32 v0, s40, v0
    v_lshlrev_b32 v0, 2, v0
    ds_read_b32 v0, v0 offset:10240
    v_max3_f32 v8, v40, v41, v42
    v_max3_f32 v9, v44, v45, v46
    v_max_f32 v8, v8, v43
    v_max_f32 v9, v9, v47
    v_fma_f32 v12, v8, s39, -v56
    v_fma_f32 v13, v9, s39, -v58
    v_max_f32 v12, v12, v13
    v_cmp_lt_f32 vcc, 0x40c00000, v12
    s_nop 0
    s_cmp_lg_u64 vcc, 0
    s_nop 1
    s_cbranch_scc1 L_rare_s2
L_back_s2:
    v_fma_f32 v40, v40, s39, -v56
    v_fma_f32 v41, v41, s39, -v56
    v_fma_f32 v42, v42, s39, -v56
    v_fma_f32 v43, v43, s39, -v56
    v_exp_f32 v40, v40
    v_exp_f32 v41, v41
    v_exp_f32 v42, v42
    v_exp_f32 v43, v43
    v_add_f32 v8, v40, v41
    v_add_f32 v9, v42, v43
    v_cvt_pk_bf16_f32 v40, v40, v40
    v_cvt_pk_bf16_f32 v41, v41, v41
    v_add_f32 v57, v57, v8
    v_cvt_pk_bf16_f32 v42, v42, v42
    v_cvt_pk_bf16_f32 v43, v43, v43
    v_add_f32 v57, v57, v9
    v_and_b32_dpp v24, v40, v5 quad_perm:[0,0,2,2] row_mask:0xf bank_mask:0xf
    v_and_b32_dpp v25, v41, v5 quad_perm:[0,0,2,2] row_mask:0xf bank_mask:0xf
    v_and_b32_dpp v26, v42, v5 quad_perm:[0,0,2,2] row_mask:0xf bank_mask:0xf
    v_and_b32_dpp v27, v43, v5 quad_perm:[0,0,2,2] row_mask:0xf bank_mask:0xf
    v_and_b32_dpp v28, v40, v5 quad_perm:[1,1,3,3] row_mask:0xf bank_mask:0xf
    v_and_b32_dpp v29, v41, v5 quad_perm:[1,1,3,3] row_mask:0xf bank_mask:0xf
    v_and_b32_dpp v30, v42, v5 quad_perm:[1,1,3,3] row_mask:0xf bank_mask:0xf
    v_and_b32_dpp v31, v43, v5 quad_perm:[1,1,3,3] row_mask:0xf bank_mask:0xf
    v_mfma_f32_16x16x32_bf16 v[64:67], v[160:163], v[24:27], v[64:67]
    v_mfma_f32_16x16x32_bf16 v[68:71], v[164:167], v[24:27], v[68:71]
    v_mfma_f32_16x16x32_bf16 v[72:75], v[168:171], v[24:27], v[72:75]
    v_mfma_f32_16x16x32_bf16 v[76:79], v[172:175], v[24:27], v[76:79]
    v_mfma_f32_16x16x32_bf16 v[96:99], v[160:163], v[28:31], v[96:99]
    v_mfma_f32_16x16x32_bf16 v[100:103], v[164:167], v[28:31], v[100:103]
    v_mfma_f32_16x16x32_bf16 v[104:107], v[168:171], v[28:31], v[104:107]
    v_mfma_f32_16x16x32_bf16 v[108:111], v[172:175], v[28:31], v[108:111]
    v_fma_f32 v44, v44, s39, -v58
    v_fma_f32 v45, v45, s39, -v58
    v_fma_f32 v46, v46, s39, -v58
    v_fma_f32 v47, v47, s39, -v58
    v_exp_f32 v44, v44
    v_exp_f32 v45, v45
    v_exp_f32 v46, v46
    v_exp_f32 v47, v47
    v_add_f32 v8, v44, v45
    v_add_f32 v9, v46, v47
    v_cvt_pk_bf16_f32 v44, v44, v44
    v_cvt_pk_bf16_f32 v45, v45, v45
    v_add_f32 v59, v59, v8
    v_cvt_pk_bf16_f32 v46, v46, v46
    v_cvt_pk_bf16_f32 v47, v47, v47
    v_add_f32 v59, v59, v9
    v_and_b32_dpp v32, v44, v5 quad_perm:[0,0,2,2] row_mask:0xf bank_mask:0xf
    v_and_b32_dpp v33, v45, v5 quad_perm:[0,0,2,2] row_mask:0xf bank_mask:0xf
    v_and_b32_dpp v34, v46, v5 quad_perm:[0,0,2,2] row_mask:0xf bank_mask:0xf
    v_and_b32_dpp v35, v47, v5 quad_perm:[0,0,2,2] row_mask:0xf bank_mask:0xf
    v_and_b32_dpp v36, v44, v5 quad_perm:[1,1,3,3] row_mask:0xf bank_mask:0xf
    v_and_b32_dpp v37, v45, v5 quad_perm:[1,1,3,3] row_mask:0xf bank_mask:0xf
    v_and_b32_dpp v38, v46, v5 quad_perm:[1,1,3,3] row_mask:0xf bank_mask:0xf
    v_and_b32_dpp v39, v47, v5 quad_perm:[1,1,3,3] row_mask:0xf bank_mask:0xf
    v_mfma_f32_16x16x32_bf16 v[80:83], v[160:163], v[32:35], v[80:83]
    v_mfma_f32_16x16x32_bf16 v[84:87], v[164:167], v[32:35], v[84:87]
    v_mfma_f32_16x16x32_bf16 v[88:91], v[168:171], v[32:35], v[88:91]
    v_mfma_f32_16x16x32_bf16 v[92:95], v[172:175], v[32:35], v[92:95]
    v_mfma_f32_16x16x32_bf16 v[112:115], v[160:163], v[36:39], v[112:115]
    v_mfma_f32_16x16x32_bf16 v[116:119], v[164:167], v[36:39], v[116:119]
    v_mfma_f32_16x16x32_bf16 v[120:123], v[168:171], v[36:39], v[120:123]
    v_mfma_f32_16x16x32_bf16 v[124:127], v[172:175], v[36:39], v[124:127]
    s_waitcnt lgkmcnt(0)
    v_readfirstlane_b32 s47, v0
    s_mov_b32 s45, s46
    s_mov_b32 s46, s24
    s_mov_b32 s24, s47
    s_mov_b32 s70, s72
    s_and_b32 s48, s24, 0xfff
    s_lshl_b32 s48, s48, 16
    s_and_b32 s22, s24, 0x1f000
    s_add_u32 s22, s22, s48
    s_add_u32 s48, s48, s38
    s_add_u32 s50, s48, 32768
    s_add_u32 s49, s48, s69
    s_add_u32 s51, s50, s69
    s_branch L_vs_0
L_rr_vs_0:
    ds_read_b32 v19, v11 offset:8448
    ds_read_b128 v[40:43], v10 offset:0
    ds_read_b128 v[44:47], v10 offset:512
    s_branch L_rs_vs_0
L_rare_s0:
    v_mov_b32 v12, v8
    v_mov_b32 v13, v9
    s_nop 0
    v_permlane32_swap_b32 v8, v12
    v_permlane32_swap_b32 v9, v13
    v_max_f32 v8, v8, v12
    v_max_f32 v9, v9, v13
    v_mov_b32 v12, v8
    v_mov_b32 v13, v9
    s_nop 0
    v_permlane16_swap_b32 v8, v12
    v_permlane16_swap_b32 v9, v13
    v_max_f32 v8, v8, v12
    v_max_f32 v9, v9, v13
    v_mul_f32 v8, s39, v8
    v_mul_f32 v9, s39, v9
    v_max_f32 v8, v8, v56
    v_max_f32 v9, v9, v58
    v_sub_f32 v12, v56, v8
    v_sub_f32 v13, v58, v9
    v_mov_b32 v56, v8
    v_mov_b32 v58, v9
    v_exp_f32 v12, v12
    v_exp_f32 v13, v13
    v_mul_f32 v57, v57, v12
    v_mul_f32 v59, v59, v13
    v_mul_f32_dpp v64, v12, v64 quad_perm:[0,0,2,2] row_mask:0xf bank_mask:0xf
    v_mul_f32_dpp v65, v12, v65 quad_perm:[0,0,2,2] row_mask:0xf bank_mask:0xf
    v_mul_f32_dpp v66, v12, v66 quad_perm:[0,0,2,2] row_mask:0xf bank_mask:0xf
    v_mul_f32_dpp v67, v12, v67 quad_perm:[0,0,2,2] row_mask:0xf bank_mask:0xf
    v_mul_f32_dpp v68, v12, v68 quad_perm:[0,0,2,2] row_mask:0xf bank_mask:0xf
    v_mul_f32_dpp v69, v12, v69 quad_perm:[0,0,2,2] row_mask:0xf bank_mask:0xf
    v_mul_f32_dpp v70, v12, v70 quad_perm:[0,0,2,2] row_mask:0xf bank_mask:0xf
    v_mul_f32_dpp v71, v12, v71 quad_perm:[0,0,2,2] row_mask:0xf bank_mask:0xf
    v_mul_f32_dpp v72, v12, v72 quad_perm:[0,0,2,2] row_mask:0xf bank_mask:0xf
    v_mul_f32_dpp v73, v12, v73 quad_perm:[0,0,2,2] row_mask:0xf bank_mask:0xf
    v_mul_f32_dpp v74, v12, v74 quad_perm:[0,0,2,2] row_mask:0xf bank_mask:0xf
    v_mul_f32_dpp v75, v12, v75 quad_perm:[0,0,2,2] row_mask:0xf bank_mask:0xf
    v_mul_f32_dpp v76, v12, v76 quad_perm:[0,0,2,2] row_mask:0xf bank_mask:0xf
    v_mul_f32_dpp v77, v12, v77 quad_perm:[0,0,2,2] row_mask:0xf bank_mask:0xf
    v_mul_f32_dpp v78, v12, v78 quad_perm:[0,0,2,2] row_mask:0xf bank_mask:0xf
    v_mul_f32_dpp v79, v12, v79 quad_perm:[0,0,2,2] row_mask:0xf bank_mask:0xf
    v_mul_f32_dpp v96, v12, v96 quad_perm:[1,1,3,3] row_mask:0xf bank_mask:0xf
    v_mul_f32_dpp v97, v12, v97 quad_perm:[1,1,3,3] row_mask:0xf bank_mask:0xf
    v_mul_f32_dpp v98, v12, v98 quad_perm:[1,1,3,3] row_mask:0xf bank_mask:0xf
    v_mul_f32_dpp v99, v12, v99 quad_perm:[1,1,3,3] row_mask:0xf bank_mask:0xf
    v_mul_f32_dpp v100, v12, v100 quad_perm:[1,1,3,3] row_mask:0xf bank_mask:0xf
    v_mul_f32_dpp v101, v12, v101 quad_perm:[1,1,3,3] row_mask:0xf bank_mask:0xf
    v_mul_f32_dpp v102, v12, v102 quad_perm:[1,1,3,3] row_mask:0xf bank_mask:0xf
    v_mul_f32_dpp v103, v12, v103 quad_perm:[1,1,3,3] row_mask:0xf bank_mask:0xf
    v_mul_f32_dpp v104, v12, v104 quad_perm:[1,1,3,3] row_mask:0xf bank_mask:0xf
    v_mul_f32_dpp v105, v12, v105 quad_perm:[1,1,3,3] row_mask:0xf bank_mask:0xf
    v_mul_f32_dpp v106, v12, v106 quad_perm:[1,1,3,3] row_mask:0xf bank_mask:0xf
    v_mul_f32_dpp v107, v12, v107 quad_perm:[1,1,3,3] row_mask:0xf bank_mask:0xf
    v_mul_f32_dpp v108, v12, v108 quad_perm:[1,1,3,3] row_mask:0xf bank_mask:0xf
    v_mul_f32_dpp v109, v12, v109 quad_perm:[1,1,3,3] row_mask:0xf bank_mask:0xf
    v_mul_f32_dpp v110, v12, v110 quad_perm:[1,1,3,3] row_mask:0xf bank_mask:0xf
    v_mul_f32_dpp v111, v12, v111 quad_perm:[1,1,3,3] row_mask:0xf bank_mask:0xf
    v_mul_f32_dpp v80, v13, v80 quad_perm:[0,0,2,2] row_mask:0xf bank_mask:0xf
    v_mul_f32_dpp v81, v13, v81 quad_perm:[0,0,2,2] row_mask:0xf bank_mask:0xf
    v_mul_f32_dpp v82, v13, v82 quad_perm:[0,0,2,2] row_mask:0xf bank_mask:0xf
    v_mul_f32_dpp v83, v13, v83 quad_perm:[0,0,2,2] row_mask:0xf bank_mask:0xf
    v_mul_f32_dpp v84, v13, v84 quad_perm:[0,0,2,2] row_mask:0xf bank_mask:0xf
    v_mul_f32_dpp v85, v13, v85 quad_perm:[0,0,2,2] row_mask:0xf bank_mask:0xf
    v_mul_f32_dpp v86, v13, v86 quad_perm:[0,0,2,2] row_mask:0xf bank_mask:0xf
    v_mul_f32_dpp v87, v13, v87 quad_perm:[0,0,2,2] row_mask:0xf bank_mask:0xf
    v_mul_f32_dpp v88, v13, v88 quad_perm:[0,0,2,2] row_mask:0xf bank_mask:0xf
    v_mul_f32_dpp v89, v13, v89 quad_perm:[0,0,2,2] row_mask:0xf bank_mask:0xf
    v_mul_f32_dpp v90, v13, v90 quad_perm:[0,0,2,2] row_mask:0xf bank_mask:0xf
    v_mul_f32_dpp v91, v13, v91 quad_perm:[0,0,2,2] row_mask:0xf bank_mask:0xf
    v_mul_f32_dpp v92, v13, v92 quad_perm:[0,0,2,2] row_mask:0xf bank_mask:0xf
    v_mul_f32_dpp v93, v13, v93 quad_perm:[0,0,2,2] row_mask:0xf bank_mask:0xf
    v_mul_f32_dpp v94, v13, v94 quad_perm:[0,0,2,2] row_mask:0xf bank_mask:0xf
    v_mul_f32_dpp v95, v13, v95 quad_perm:[0,0,2,2] row_mask:0xf bank_mask:0xf
    v_mul_f32_dpp v112, v13, v112 quad_perm:[1,1,3,3] row_mask:0xf bank_mask:0xf
    v_mul_f32_dpp v113, v13, v113 quad_perm:[1,1,3,3] row_mask:0xf bank_mask:0xf
    v_mul_f32_dpp v114, v13, v114 quad_perm:[1,1,3,3] row_mask:0xf bank_mask:0xf
    v_mul_f32_dpp v115, v13, v115 quad_perm:[1,1,3,3] row_mask:0xf bank_mask:0xf
    v_mul_f32_dpp v116, v13, v116 quad_perm:[1,1,3,3] row_mask:0xf bank_mask:0xf
    v_mul_f32_dpp v117, v13, v117 quad_perm:[1,1,3,3] row_mask:0xf bank_mask:0xf
    v_mul_f32_dpp v118, v13, v118 quad_perm:[1,1,3,3] row_mask:0xf bank_mask:0xf
    v_mul_f32_dpp v119, v13, v119 quad_perm:[1,1,3,3] row_mask:0xf bank_mask:0xf
    v_mul_f32_dpp v120, v13, v120 quad_perm:[1,1,3,3] row_mask:0xf bank_mask:0xf
    v_mul_f32_dpp v121, v13, v121 quad_perm:[1,1,3,3] row_mask:0xf bank_mask:0xf
    v_mul_f32_dpp v122, v13, v122 quad_perm:[1,1,3,3] row_mask:0xf bank_mask:0xf
    v_mul_f32_dpp v123, v13, v123 quad_perm:[1,1,3,3] row_mask:0xf bank_mask:0xf
    v_mul_f32_dpp v124, v13, v124 quad_perm:[1,1,3,3] row_mask:0xf bank_mask:0xf
    v_mul_f32_dpp v125, v13, v125 quad_perm:[1,1,3,3] row_mask:0xf bank_mask:0xf
    v_mul_f32_dpp v126, v13, v126 quad_perm:[1,1,3,3] row_mask:0xf bank_mask:0xf
    v_mul_f32_dpp v127, v13, v127 quad_perm:[1,1,3,3] row_mask:0xf bank_mask:0xf
    s_nop 0
    s_branch L_back_s0
L_rr_vs_1:
    ds_read_b32 v19, v11 offset:8448
    ds_read_b128 v[40:43], v10 offset:0
    ds_read_b128 v[44:47], v10 offset:512
    s_branch L_rs_vs_1
L_rare_s1:
    v_mov_b32 v12, v8
    v_mov_b32 v13, v9
    s_nop 0
    v_permlane32_swap_b32 v8, v12
    v_permlane32_swap_b32 v9, v13
    v_max_f32 v8, v8, v12
    v_max_f32 v9, v9, v13
    v_mov_b32 v12, v8
    v_mov_b32 v13, v9
    s_nop 0
    v_permlane16_swap_b32 v8, v12
    v_permlane16_swap_b32 v9, v13
    v_max_f32 v8, v8, v12
    v_max_f32 v9, v9, v13
    v_mul_f32 v8, s39, v8
    v_mul_f32 v9, s39, v9
    v_max_f32 v8, v8, v56
    v_max_f32 v9, v9, v58
    v_sub_f32 v12, v56, v8
    v_sub_f32 v13, v58, v9
    v_mov_b32 v56, v8
    v_mov_b32 v58, v9
    v_exp_f32 v12, v12
    v_exp_f32 v13, v13
    v_mul_f32 v57, v57, v12
    v_mul_f32 v59, v59, v13
    v_mul_f32_dpp v64, v12, v64 quad_perm:[0,0,2,2] row_mask:0xf bank_mask:0xf
    v_mul_f32_dpp v65, v12, v65 quad_perm:[0,0,2,2] row_mask:0xf bank_mask:0xf
    v_mul_f32_dpp v66, v12, v66 quad_perm:[0,0,2,2] row_mask:0xf bank_mask:0xf
    v_mul_f32_dpp v67, v12, v67 quad_perm:[0,0,2,2] row_mask:0xf bank_mask:0xf
    v_mul_f32_dpp v68, v12, v68 quad_perm:[0,0,2,2] row_mask:0xf bank_mask:0xf
    v_mul_f32_dpp v69, v12, v69 quad_perm:[0,0,2,2] row_mask:0xf bank_mask:0xf
    v_mul_f32_dpp v70, v12, v70 quad_perm:[0,0,2,2] row_mask:0xf bank_mask:0xf
    v_mul_f32_dpp v71, v12, v71 quad_perm:[0,0,2,2] row_mask:0xf bank_mask:0xf
    v_mul_f32_dpp v72, v12, v72 quad_perm:[0,0,2,2] row_mask:0xf bank_mask:0xf
    v_mul_f32_dpp v73, v12, v73 quad_perm:[0,0,2,2] row_mask:0xf bank_mask:0xf
    v_mul_f32_dpp v74, v12, v74 quad_perm:[0,0,2,2] row_mask:0xf bank_mask:0xf
    v_mul_f32_dpp v75, v12, v75 quad_perm:[0,0,2,2] row_mask:0xf bank_mask:0xf
    v_mul_f32_dpp v76, v12, v76 quad_perm:[0,0,2,2] row_mask:0xf bank_mask:0xf
    v_mul_f32_dpp v77, v12, v77 quad_perm:[0,0,2,2] row_mask:0xf bank_mask:0xf
    v_mul_f32_dpp v78, v12, v78 quad_perm:[0,0,2,2] row_mask:0xf bank_mask:0xf
    v_mul_f32_dpp v79, v12, v79 quad_perm:[0,0,2,2] row_mask:0xf bank_mask:0xf
    v_mul_f32_dpp v96, v12, v96 quad_perm:[1,1,3,3] row_mask:0xf bank_mask:0xf
    v_mul_f32_dpp v97, v12, v97 quad_perm:[1,1,3,3] row_mask:0xf bank_mask:0xf
    v_mul_f32_dpp v98, v12, v98 quad_perm:[1,1,3,3] row_mask:0xf bank_mask:0xf
    v_mul_f32_dpp v99, v12, v99 quad_perm:[1,1,3,3] row_mask:0xf bank_mask:0xf
    v_mul_f32_dpp v100, v12, v100 quad_perm:[1,1,3,3] row_mask:0xf bank_mask:0xf
    v_mul_f32_dpp v101, v12, v101 quad_perm:[1,1,3,3] row_mask:0xf bank_mask:0xf
    v_mul_f32_dpp v102, v12, v102 quad_perm:[1,1,3,3] row_mask:0xf bank_mask:0xf
    v_mul_f32_dpp v103, v12, v103 quad_perm:[1,1,3,3] row_mask:0xf bank_mask:0xf
    v_mul_f32_dpp v104, v12, v104 quad_perm:[1,1,3,3] row_mask:0xf bank_mask:0xf
    v_mul_f32_dpp v105, v12, v105 quad_perm:[1,1,3,3] row_mask:0xf bank_mask:0xf
    v_mul_f32_dpp v106, v12, v106 quad_perm:[1,1,3,3] row_mask:0xf bank_mask:0xf
    v_mul_f32_dpp v107, v12, v107 quad_perm:[1,1,3,3] row_mask:0xf bank_mask:0xf
    v_mul_f32_dpp v108, v12, v108 quad_perm:[1,1,3,3] row_mask:0xf bank_mask:0xf
    v_mul_f32_dpp v109, v12, v109 quad_perm:[1,1,3,3] row_mask:0xf bank_mask:0xf
    v_mul_f32_dpp v110, v12, v110 quad_perm:[1,1,3,3] row_mask:0xf bank_mask:0xf
    v_mul_f32_dpp v111, v12, v111 quad_perm:[1,1,3,3] row_mask:0xf bank_mask:0xf
    v_mul_f32_dpp v80, v13, v80 quad_perm:[0,0,2,2] row_mask:0xf bank_mask:0xf
    v_mul_f32_dpp v81, v13, v81 quad_perm:[0,0,2,2] row_mask:0xf bank_mask:0xf
    v_mul_f32_dpp v82, v13, v82 quad_perm:[0,0,2,2] row_mask:0xf bank_mask:0xf
    v_mul_f32_dpp v83, v13, v83 quad_perm:[0,0,2,2] row_mask:0xf bank_mask:0xf
    v_mul_f32_dpp v84, v13, v84 quad_perm:[0,0,2,2] row_mask:0xf bank_mask:0xf
    v_mul_f32_dpp v85, v13, v85 quad_perm:[0,0,2,2] row_mask:0xf bank_mask:0xf
    v_mul_f32_dpp v86, v13, v86 quad_perm:[0,0,2,2] row_mask:0xf bank_mask:0xf
    v_mul_f32_dpp v87, v13, v87 quad_perm:[0,0,2,2] row_mask:0xf bank_mask:0xf
    v_mul_f32_dpp v88, v13, v88 quad_perm:[0,0,2,2] row_mask:0xf bank_mask:0xf
    v_mul_f32_dpp v89, v13, v89 quad_perm:[0,0,2,2] row_mask:0xf bank_mask:0xf
    v_mul_f32_dpp v90, v13, v90 quad_perm:[0,0,2,2] row_mask:0xf bank_mask:0xf
    v_mul_f32_dpp v91, v13, v91 quad_perm:[0,0,2,2] row_mask:0xf bank_mask:0xf
    v_mul_f32_dpp v92, v13, v92 quad_perm:[0,0,2,2] row_mask:0xf bank_mask:0xf
    v_mul_f32_dpp v93, v13, v93 quad_perm:[0,0,2,2] row_mask:0xf bank_mask:0xf
    v_mul_f32_dpp v94, v13, v94 quad_perm:[0,0,2,2] row_mask:0xf bank_mask:0xf
    v_mul_f32_dpp v95, v13, v95 quad_perm:[0,0,2,2] row_mask:0xf bank_mask:0xf
    v_mul_f32_dpp v112, v13, v112 quad_perm:[1,1,3,3] row_mask:0xf bank_mask:0xf
    v_mul_f32_dpp v113, v13, v113 quad_perm:[1,1,3,3] row_mask:0xf bank_mask:0xf
    v_mul_f32_dpp v114, v13, v114 quad_perm:[1,1,3,3] row_mask:0xf bank_mask:0xf
    v_mul_f32_dpp v115, v13, v115 quad_perm:[1,1,3,3] row_mask:0xf bank_mask:0xf
    v_mul_f32_dpp v116, v13, v116 quad_perm:[1,1,3,3] row_mask:0xf bank_mask:0xf
    v_mul_f32_dpp v117, v13, v117 quad_perm:[1,1,3,3] row_mask:0xf bank_mask:0xf
    v_mul_f32_dpp v118, v13, v118 quad_perm:[1,1,3,3] row_mask:0xf bank_mask:0xf
    v_mul_f32_dpp v119, v13, v119 quad_perm:[1,1,3,3] row_mask:0xf bank_mask:0xf
    v_mul_f32_dpp v120, v13, v120 quad_perm:[1,1,3,3] row_mask:0xf bank_mask:0xf
    v_mul_f32_dpp v121, v13, v121 quad_perm:[1,1,3,3] row_mask:0xf bank_mask:0xf
    v_mul_f32_dpp v122, v13, v122 quad_perm:[1,1,3,3] row_mask:0xf bank_mask:0xf
    v_mul_f32_dpp v123, v13, v123 quad_perm:[1,1,3,3] row_mask:0xf bank_mask:0xf
    v_mul_f32_dpp v124, v13, v124 quad_perm:[1,1,3,3] row_mask:0xf bank_mask:0xf
    v_mul_f32_dpp v125, v13, v125 quad_perm:[1,1,3,3] row_mask:0xf bank_mask:0xf
    v_mul_f32_dpp v126, v13, v126 quad_perm:[1,1,3,3] row_mask:0xf bank_mask:0xf
    v_mul_f32_dpp v127, v13, v127 quad_perm:[1,1,3,3] row_mask:0xf bank_mask:0xf
    s_nop 0
    s_branch L_back_s1
L_rr_vs_2:
    ds_read_b32 v19, v11 offset:8448
    ds_read_b128 v[40:43], v10 offset:0
    ds_read_b128 v[44:47], v10 offset:512
    s_branch L_rs_vs_2
L_rare_s2:
    v_mov_b32 v12, v8
    v_mov_b32 v13, v9
    s_nop 0
    v_permlane32_swap_b32 v8, v12
    v_permlane32_swap_b32 v9, v13
    v_max_f32 v8, v8, v12
    v_max_f32 v9, v9, v13
    v_mov_b32 v12, v8
    v_mov_b32 v13, v9
    s_nop 0
    v_permlane16_swap_b32 v8, v12
    v_permlane16_swap_b32 v9, v13
    v_max_f32 v8, v8, v12
    v_max_f32 v9, v9, v13
    v_mul_f32 v8, s39, v8
    v_mul_f32 v9, s39, v9
    v_max_f32 v8, v8, v56
    v_max_f32 v9, v9, v58
    v_sub_f32 v12, v56, v8
    v_sub_f32 v13, v58, v9
    v_mov_b32 v56, v8
    v_mov_b32 v58, v9
    v_exp_f32 v12, v12
    v_exp_f32 v13, v13
    v_mul_f32 v57, v57, v12
    v_mul_f32 v59, v59, v13
    v_mul_f32_dpp v64, v12, v64 quad_perm:[0,0,2,2] row_mask:0xf bank_mask:0xf
    v_mul_f32_dpp v65, v12, v65 quad_perm:[0,0,2,2] row_mask:0xf bank_mask:0xf
    v_mul_f32_dpp v66, v12, v66 quad_perm:[0,0,2,2] row_mask:0xf bank_mask:0xf
    v_mul_f32_dpp v67, v12, v67 quad_perm:[0,0,2,2] row_mask:0xf bank_mask:0xf
    v_mul_f32_dpp v68, v12, v68 quad_perm:[0,0,2,2] row_mask:0xf bank_mask:0xf
    v_mul_f32_dpp v69, v12, v69 quad_perm:[0,0,2,2] row_mask:0xf bank_mask:0xf
    v_mul_f32_dpp v70, v12, v70 quad_perm:[0,0,2,2] row_mask:0xf bank_mask:0xf
    v_mul_f32_dpp v71, v12, v71 quad_perm:[0,0,2,2] row_mask:0xf bank_mask:0xf
    v_mul_f32_dpp v72, v12, v72 quad_perm:[0,0,2,2] row_mask:0xf bank_mask:0xf
    v_mul_f32_dpp v73, v12, v73 quad_perm:[0,0,2,2] row_mask:0xf bank_mask:0xf
    v_mul_f32_dpp v74, v12, v74 quad_perm:[0,0,2,2] row_mask:0xf bank_mask:0xf
    v_mul_f32_dpp v75, v12, v75 quad_perm:[0,0,2,2] row_mask:0xf bank_mask:0xf
    v_mul_f32_dpp v76, v12, v76 quad_perm:[0,0,2,2] row_mask:0xf bank_mask:0xf
    v_mul_f32_dpp v77, v12, v77 quad_perm:[0,0,2,2] row_mask:0xf bank_mask:0xf
    v_mul_f32_dpp v78, v12, v78 quad_perm:[0,0,2,2] row_mask:0xf bank_mask:0xf
    v_mul_f32_dpp v79, v12, v79 quad_perm:[0,0,2,2] row_mask:0xf bank_mask:0xf
    v_mul_f32_dpp v96, v12, v96 quad_perm:[1,1,3,3] row_mask:0xf bank_mask:0xf
    v_mul_f32_dpp v97, v12, v97 quad_perm:[1,1,3,3] row_mask:0xf bank_mask:0xf
    v_mul_f32_dpp v98, v12, v98 quad_perm:[1,1,3,3] row_mask:0xf bank_mask:0xf
    v_mul_f32_dpp v99, v12, v99 quad_perm:[1,1,3,3] row_mask:0xf bank_mask:0xf
    v_mul_f32_dpp v100, v12, v100 quad_perm:[1,1,3,3] row_mask:0xf bank_mask:0xf
    v_mul_f32_dpp v101, v12, v101 quad_perm:[1,1,3,3] row_mask:0xf bank_mask:0xf
    v_mul_f32_dpp v102, v12, v102 quad_perm:[1,1,3,3] row_mask:0xf bank_mask:0xf
    v_mul_f32_dpp v103, v12, v103 quad_perm:[1,1,3,3] row_mask:0xf bank_mask:0xf
    v_mul_f32_dpp v104, v12, v104 quad_perm:[1,1,3,3] row_mask:0xf bank_mask:0xf
    v_mul_f32_dpp v105, v12, v105 quad_perm:[1,1,3,3] row_mask:0xf bank_mask:0xf
    v_mul_f32_dpp v106, v12, v106 quad_perm:[1,1,3,3] row_mask:0xf bank_mask:0xf
    v_mul_f32_dpp v107, v12, v107 quad_perm:[1,1,3,3] row_mask:0xf bank_mask:0xf
    v_mul_f32_dpp v108, v12, v108 quad_perm:[1,1,3,3] row_mask:0xf bank_mask:0xf
    v_mul_f32_dpp v109, v12, v109 quad_perm:[1,1,3,3] row_mask:0xf bank_mask:0xf
    v_mul_f32_dpp v110, v12, v110 quad_perm:[1,1,3,3] row_mask:0xf bank_mask:0xf
    v_mul_f32_dpp v111, v12, v111 quad_perm:[1,1,3,3] row_mask:0xf bank_mask:0xf
    v_mul_f32_dpp v80, v13, v80 quad_perm:[0,0,2,2] row_mask:0xf bank_mask:0xf
    v_mul_f32_dpp v81, v13, v81 quad_perm:[0,0,2,2] row_mask:0xf bank_mask:0xf
    v_mul_f32_dpp v82, v13, v82 quad_perm:[0,0,2,2] row_mask:0xf bank_mask:0xf
    v_mul_f32_dpp v83, v13, v83 quad_perm:[0,0,2,2] row_mask:0xf bank_mask:0xf
    v_mul_f32_dpp v84, v13, v84 quad_perm:[0,0,2,2] row_mask:0xf bank_mask:0xf
    v_mul_f32_dpp v85, v13, v85 quad_perm:[0,0,2,2] row_mask:0xf bank_mask:0xf
    v_mul_f32_dpp v86, v13, v86 quad_perm:[0,0,2,2] row_mask:0xf bank_mask:0xf
    v_mul_f32_dpp v87, v13, v87 quad_perm:[0,0,2,2] row_mask:0xf bank_mask:0xf
    v_mul_f32_dpp v88, v13, v88 quad_perm:[0,0,2,2] row_mask:0xf bank_mask:0xf
    v_mul_f32_dpp v89, v13, v89 quad_perm:[0,0,2,2] row_mask:0xf bank_mask:0xf
    v_mul_f32_dpp v90, v13, v90 quad_perm:[0,0,2,2] row_mask:0xf bank_mask:0xf
    v_mul_f32_dpp v91, v13, v91 quad_perm:[0,0,2,2] row_mask:0xf bank_mask:0xf
    v_mul_f32_dpp v92, v13, v92 quad_perm:[0,0,2,2] row_mask:0xf bank_mask:0xf
    v_mul_f32_dpp v93, v13, v93 quad_perm:[0,0,2,2] row_mask:0xf bank_mask:0xf
    v_mul_f32_dpp v94, v13, v94 quad_perm:[0,0,2,2] row_mask:0xf bank_mask:0xf
    v_mul_f32_dpp v95, v13, v95 quad_perm:[0,0,2,2] row_mask:0xf bank_mask:0xf
    v_mul_f32_dpp v112, v13, v112 quad_perm:[1,1,3,3] row_mask:0xf bank_mask:0xf
    v_mul_f32_dpp v113, v13, v113 quad_perm:[1,1,3,3] row_mask:0xf bank_mask:0xf
    v_mul_f32_dpp v114, v13, v114 quad_perm:[1,1,3,3] row_mask:0xf bank_mask:0xf
    v_mul_f32_dpp v115, v13, v115 quad_perm:[1,1,3,3] row_mask:0xf bank_mask:0xf
    v_mul_f32_dpp v116, v13, v116 quad_perm:[1,1,3,3] row_mask:0xf bank_mask:0xf
    v_mul_f32_dpp v117, v13, v117 quad_perm:[1,1,3,3] row_mask:0xf bank_mask:0xf
    v_mul_f32_dpp v118, v13, v118 quad_perm:[1,1,3,3] row_mask:0xf bank_mask:0xf
    v_mul_f32_dpp v119, v13, v119 quad_perm:[1,1,3,3] row_mask:0xf bank_mask:0xf
    v_mul_f32_dpp v120, v13, v120 quad_perm:[1,1,3,3] row_mask:0xf bank_mask:0xf
    v_mul_f32_dpp v121, v13, v121 quad_perm:[1,1,3,3] row_mask:0xf bank_mask:0xf
    v_mul_f32_dpp v122, v13, v122 quad_perm:[1,1,3,3] row_mask:0xf bank_mask:0xf
    v_mul_f32_dpp v123, v13, v123 quad_perm:[1,1,3,3] row_mask:0xf bank_mask:0xf
    v_mul_f32_dpp v124, v13, v124 quad_perm:[1,1,3,3] row_mask:0xf bank_mask:0xf
    v_mul_f32_dpp v125, v13, v125 quad_perm:[1,1,3,3] row_mask:0xf bank_mask:0xf
    v_mul_f32_dpp v126, v13, v126 quad_perm:[1,1,3,3] row_mask:0xf bank_mask:0xf
    v_mul_f32_dpp v127, v13, v127 quad_perm:[1,1,3,3] row_mask:0xf bank_mask:0xf
    s_nop 0
    s_branch L_back_s2
L_flush_sh:
    s_mov_b64 exec, 1
    ds_add_u32 v6, v7 offset:8
    s_mov_b64 exec, -1
L_fs_wait:
    ds_read_b32 v8, v6 offset:8
    s_waitcnt lgkmcnt(0)
    v_readfirstlane_b32 s55, v8
    s_nop 0
    s_cmp_lt_u32 s55, 3
    s_nop 1
    s_cbranch_scc1 L_fs_wait
    v_bfe_u32 v8, v1, 2, 2
    v_lshlrev_b32 v9, 10, v8
    v_lshrrev_b32 v10, 4, v1
    v_lshl_add_u32 v9, v10, 8, v9
    v_bfe_u32 v11, v1, 1, 1
    v_lshl_add_u32 v9, v11, 7, v9
    v_and_b32 v12, 1, v1
    v_lshl_add_u32 v9, v12, 4, v9
    s_lshl_b32 s54, s3, 14
    s_add_u32 s54, s54, 64256
    v_add_u32 v9, s54, v9
    v_bfe_u32 v13, v1, 1, 2
    v_lshl_add_u32 v9, v13, 5, v9
    ds_write_b128 v9, v[64:67] offset:0
    ds_write_b128 v9, v[80:83] offset:4096
    ds_write_b128 v9, v[96:99] offset:8192
    ds_write_b128 v9, v[112:115] offset:12288
    v_xor_b32 v13, 32, v9
    ds_write_b128 v13, v[68:71] offset:0
    ds_write_b128 v13, v[84:87] offset:4096
    ds_write_b128 v13, v[100:103] offset:8192
    ds_write_b128 v13, v[116:119] offset:12288
    v_xor_b32 v13, 64, v9
    ds_write_b128 v13, v[72:75] offset:0
    ds_write_b128 v13, v[88:91] offset:4096
    ds_write_b128 v13, v[104:107] offset:8192
    ds_write_b128 v13, v[120:123] offset:12288
    v_xor_b32 v13, 96, v9
    ds_write_b128 v13, v[76:79] offset:0
    ds_write_b128 v13, v[92:95] offset:4096
    ds_write_b128 v13, v[108:111] offset:8192
    ds_write_b128 v13, v[124:127] offset:12288
    v_lshlrev_b32 v9, 6, v8
    v_lshl_add_u32 v9, v10, 4, v9
    v_lshl_add_u32 v9, v11, 3, v9
    s_lshl_b32 s54, s3, 10
    s_add_u32 s54, s54, 113408
    v_add_u32 v9, s54, v9
    v_lshl_add_u32 v9, v12, 9, v9
    ds_write_b64 v9, v[56:57] offset:0
    ds_write_b64 v9, v[58:59] offset:256
    s_branch L_seg_done
L_restart:
    s_waitcnt vmcnt(0) lgkmcnt(0)
    s_barrier
    s_mov_b32 s22, 142606336
    s_mov_b32 s52, 12
    s_mov_b32 s25, 2
    s_mov_b32 s42, 31
    s_mov_b32 s70, s72
    s_mov_b64 exec, 1
    ds_add_rtn_u32 v0, v6, v7
    s_mov_b64 exec, -1
    s_waitcnt lgkmcnt(0)
    v_min_u32 v0, s40, v0
    v_lshlrev_b32 v0, 2, v0
    ds_read_b32 v0, v0 offset:10240
    s_waitcnt lgkmcnt(0)
    v_readfirstlane_b32 s47, v0
    s_nop 0
    s_mov_b32 s45, s47
    s_mov_b64 exec, 1
    ds_add_rtn_u32 v0, v6, v7
    s_mov_b64 exec, -1
    s_waitcnt lgkmcnt(0)
    v_min_u32 v0, s40, v0
    v_lshlrev_b32 v0, 2, v0
    ds_read_b32 v0, v0 offset:10240
    s_waitcnt lgkmcnt(0)
    v_readfirstlane_b32 s47, v0
    s_nop 0
    s_mov_b32 s46, s47
    s_mov_b64 exec, 1
    ds_add_rtn_u32 v0, v6, v7
    s_mov_b64 exec, -1
    s_waitcnt lgkmcnt(0)
    v_min_u32 v0, s40, v0
    v_lshlrev_b32 v0, 2, v0
    ds_read_b32 v0, v0 offset:10240
    s_waitcnt lgkmcnt(0)
    v_readfirstlane_b32 s47, v0
    s_nop 0
    s_mov_b32 s24, s47
    s_mov_b64 s[20:21], s[6:7]
    s_mov_b32 s69, 128
    v_mov_b32 v16, v2
    s_bitcmp1_b32 s45, 31
    s_cbranch_scc1 L_ph_52
L_ph_53:
    s_and_b32 s48, s45, 0xfff
    s_lshl_b32 s48, s48, 16
    s_and_b32 s22, s45, 0x1f000
    s_add_u32 s22, s22, s48
    s_add_u32 s48, s48, s38
    s_add_u32 s50, s48, 32768
    s_add_u32 s49, s48, s69
    s_add_u32 s51, s50, s69
    buffer_load_dwordx4 v[128:131], v16, s[20:23], s48 offen nt
    buffer_load_dwordx4 v[132:135], v16, s[20:23], s49 offen nt
    buffer_load_dwordx4 v[136:139], v16, s[20:23], s50 offen nt
    buffer_load_dwordx4 v[140:143], v16, s[20:23], s51 offen nt
    s_bitcmp1_b32 s46, 31
    s_cbranch_scc1 L_ph_54
L_ph_55:
    s_and_b32 s48, s46, 0xfff
    s_lshl_b32 s48, s48, 16
    s_and_b32 s22, s46, 0x1f000
    s_add_u32 s22, s22, s48
    s_add_u32 s48, s48, s38
    s_add_u32 s50, s48, 32768
    s_add_u32 s49, s48, s69
    s_add_u32 s51, s50, s69
    buffer_load_dwordx4 v[144:147], v16, s[20:23], s48 offen nt
    buffer_load_dwordx4 v[148:151], v16, s[20:23], s49 offen nt
    buffer_load_dwordx4 v[152:155], v16, s[20:23], s50 offen nt
    buffer_load_dwordx4 v[156:159], v16, s[20:23], s51 offen nt
    s_bitcmp1_b32 s24, 31
    s_cbranch_scc1 L_ph_56
L_ph_57:
    s_and_b32 s48, s24, 0xfff
    s_lshl_b32 s48, s48, 16
    s_and_b32 s22, s24, 0x1f000
    s_add_u32 s22, s22, s48
    s_add_u32 s48, s48, s38
    s_add_u32 s50, s48, 32768
    s_add_u32 s49, s48, s69
    s_add_u32 s51, s50, s69
    s_branch L_switch_0
L_boost:
    s_waitcnt lgkmcnt(0)
    v_lshlrev_b32 v4, 1, v11
    v_lshlrev_b32 v8, 4, v8
    v_mov_b32 v9, 0xffff
    v_lshlrev_b32 v5, v8, v9
    v_mov_b32 v6, 8256
    v_mov_b32 v7, 1
    s_mov_b32 s39, 0x3e0293ee
    s_mov_b32 s53, 0
    s_mov_b32 s52, 3
    s_mov_b32 s40, 0
    s_and_b32 s70, s36, 3
    s_cmp_lg_u32 s70, 1
    s_cselect_b32 s70, 1, 0
    s_mov_b32 s72, s70
    s_mov_b32 s25, 1
    s_mov_b32 s26, 0
    s_mov_b32 s27, 0
    v_and_b32 v17, 0x38, v1
    v_lshlrev_b32 v17, 1, v17
    v_add_u32 v17, 29952, v17
    v_lshrrev_b32 v18, 1, v1
    v_lshlrev_b32 v18, 4, v18
    v_add_u32 v18, 64256, v18
    v_and_b32 v60, 1, v1
    v_lshl_add_u32 v60, v60, 10, v18
    v_bfe_u32 v8, v1, 1, 2
    v_cmp_eq_u32 vcc, 0, v8
    s_nop 1
    v_cndmask_b32 v20, 0, v5, vcc
    v_cmp_eq_u32 vcc, 1, v8
    s_nop 1
    v_cndmask_b32 v21, 0, v5, vcc
    v_cmp_eq_u32 vcc, 2, v8
    s_nop 1
    v_cndmask_b32 v22, 0, v5, vcc
    v_cmp_eq_u32 vcc, 3, v8
    s_nop 1
    v_cndmask_b32 v23, 0, v5, vcc
    s_sub_u32 s3, s3, 1
    s_barrier
L_boost_w:
    s_sleep 8
    v_mov_b32 v14, 8192
    ds_read_b64 v[14:15], v14
    s_waitcnt lgkmcnt(0)
    v_readfirstlane_b32 s41, v14
    v_readfirstlane_b32 s56, v15
    s_cmp_eq_u32 s41, 0
    s_nop 2
    s_cbranch_scc1 L_boost_w
    s_bfe_u32 s40, s41, 655378
    s_bitcmp1_b32 s41, 31
    s_cbranch_scc1 L_boost_w2
    s_barrier
    s_mov_b32 s25, 2
L_boost_w2:
    s_sleep 4
    v_mov_b32 v14, 8192
    ds_read_b32 v0, v6
    ds_read_b32 v15, v14 offset:4
    s_waitcnt lgkmcnt(0)
    v_readfirstlane_b32 s54, v0
    v_readfirstlane_b32 s56, v15
    s_nop 0
    s_cmp_lt_u32 s54, s56
    s_nop 1
    s_cbranch_scc1 L_boost_w2
    s_mov_b32 s53, 1
    s_mov_b32 s52, 12
    s_mov_b32 s42, 31
    s_mov_b32 s41, 131072
    s_mov_b64 s[20:21], s[6:7]
    s_mov_b32 s69, 128
    v_mov_b32 v16, v2
    s_mov_b64 exec, 1
    ds_add_rtn_u32 v0, v6, v7
    s_mov_b64 exec, -1
    s_waitcnt lgkmcnt(0)
    v_min_u32 v0, s40, v0
    v_lshlrev_b32 v0, 2, v0
    ds_read_b32 v0, v0 offset:10240
    s_waitcnt lgkmcnt(0)
    v_readfirstlane_b32 s47, v0
    s_nop 0
    s_mov_b32 s45, s47
    s_bitcmp1_b32 s45, 31
    s_nop 0
    s_cbranch_scc1 L_ph_58
L_ph_59:
    s_and_b32 s48, s45, 0xfff
    s_lshl_b32 s48, s48, 16
    s_and_b32 s22, s45, 0x1f000
    s_add_u32 s22, s22, s48
    s_add_u32 s48, s48, s38
    s_add_u32 s50, s48, 32768
    s_add_u32 s49, s48, s69
    s_add_u32 s51, s50, s69
    buffer_load_dwordx4 v[128:131], v16, s[20:23], s48 offen nt
    buffer_load_dwordx4 v[132:135], v16, s[20:23], s49 offen nt
    buffer_load_dwordx4 v[136:139], v16, s[20:23], s50 offen nt
    buffer_load_dwordx4 v[140:143], v16, s[20:23], s51 offen nt
    s_mov_b64 exec, 1
    ds_add_rtn_u32 v0, v6, v7
    s_mov_b64 exec, -1
    s_waitcnt lgkmcnt(0)
    v_min_u32 v0, s40, v0
    v_lshlrev_b32 v0, 2, v0
    ds_read_b32 v0, v0 offset:10240
    s_waitcnt lgkmcnt(0)
    v_readfirstlane_b32 s47, v0
    s_nop 0
    s_mov_b32 s46, s47
    s_bitcmp1_b32 s46, 31
    s_nop 0
    s_cbranch_scc1 L_ph_60
L_ph_61:
    s_and_b32 s48, s46, 0xfff
    s_lshl_b32 s48, s48, 16
    s_and_b32 s22, s46, 0x1f000
    s_add_u32 s22, s22, s48
    s_add_u32 s48, s48, s38
    s_add_u32 s50, s48, 32768
    s_add_u32 s49, s48, s69
    s_add_u32 s51, s50, s69
    buffer_load_dwordx4 v[144:147], v16, s[20:23], s48 offen nt
    buffer_load_dwordx4 v[148:151], v16, s[20:23], s49 offen nt
    buffer_load_dwordx4 v[152:155], v16, s[20:23], s50 offen nt
    buffer_load_dwordx4 v[156:159], v16, s[20:23], s51 offen nt
    s_mov_b64 exec, 1
    ds_add_rtn_u32 v0, v6, v7
    s_mov_b64 exec, -1
    s_waitcnt lgkmcnt(0)
    v_min_u32 v0, s40, v0
    v_lshlrev_b32 v0, 2, v0
    ds_read_b32 v0, v0 offset:10240
    s_waitcnt lgkmcnt(0)
    v_readfirstlane_b32 s47, v0
    s_nop 0
    s_mov_b32 s24, s47
    s_bitcmp1_b32 s24, 31
    s_nop 0
    s_cbranch_scc1 L_ph_62
L_ph_63:
    s_and_b32 s48, s24, 0xfff
    s_lshl_b32 s48, s48, 16
    s_and_b32 s22, s24, 0x1f000
    s_add_u32 s22, s22, s48
    s_add_u32 s48, s48, s38
    s_add_u32 s50, s48, 32768
    s_add_u32 s49, s48, s69
    s_add_u32 s51, s50, s69
    s_branch L_switch_0
L_ph_6:
    s_mov_b64 s[20:21], s[8:9]
    s_mov_b32 s69, 4096
    v_mov_b32 v16, v3
    s_nop 0
    s_branch L_ph_7
L_ph_12:
    s_mov_b64 s[20:21], s[8:9]
    s_mov_b32 s69, 4096
    v_mov_b32 v16, v3
    s_nop 0
    s_branch L_ph_13
L_ph_18:
    s_mov_b64 s[20:21], s[8:9]
    s_mov_b32 s69, 4096
    v_mov_b32 v16, v3
    s_nop 0
    s_branch L_ph_19
L_ph_35:
    s_mov_b64 s[20:21], s[8:9]
    s_mov_b32 s69, 4096
    v_mov_b32 v16, v3
    s_nop 0
    s_branch L_ph_36
L_ph_41:
    s_mov_b64 s[20:21], s[8:9]
    s_mov_b32 s69, 4096
    v_mov_b32 v16, v3
    s_nop 0
    s_branch L_ph_42
L_ph_47:
    s_mov_b64 s[20:21], s[8:9]
    s_mov_b32 s69, 4096
    v_mov_b32 v16, v3
    s_nop 0
    s_branch L_ph_48
L_ph_52:
    s_mov_b64 s[20:21], s[8:9]
    s_mov_b32 s69, 4096
    v_mov_b32 v16, v3
    s_nop 0
    s_branch L_ph_53
L_ph_54:
    s_mov_b64 s[20:21], s[8:9]
    s_mov_b32 s69, 4096
    v_mov_b32 v16, v3
    s_nop 0
    s_branch L_ph_55
L_ph_56:
    s_mov_b64 s[20:21], s[8:9]
    s_mov_b32 s69, 4096
    v_mov_b32 v16, v3
    s_nop 0
    s_branch L_ph_57
L_ph_58:
    s_mov_b64 s[20:21], s[8:9]
    s_mov_b32 s69, 4096
    v_mov_b32 v16, v3
    s_nop 0
    s_branch L_ph_59
L_ph_60:
    s_mov_b64 s[20:21], s[8:9]
    s_mov_b32 s69, 4096
    v_mov_b32 v16, v3
    s_nop 0
    s_branch L_ph_61
L_ph_62:
    s_mov_b64 s[20:21], s[8:9]
    s_mov_b32 s69, 4096
    v_mov_b32 v16, v3
    s_nop 0
    s_branch L_ph_63
L_service:
    s_setprio 3
    v_lshlrev_b32 v17, 4, v1
    v_and_b32 v40, 15, v1
    v_lshlrev_b32 v18, 2, v40
    v_add_u32 v9, 4096, v17
    v_add_u32 v10, 8192, v17
    v_add_u32 v11, 12288, v17
    v_lshrrev_b32 v19, 5, v1
    v_lshlrev_b32 v19, 13, v19
    v_and_b32 v12, 31, v1
    v_lshl_add_u32 v19, v12, 4, v19
    s_lshl_b32 s55, s36, 9
    v_add_u32 v19, s55, v19
    v_lshlrev_b32 v12, 2, v1
    v_mov_b32 v44, 0
    v_mov_b32 v45, 0
    v_mov_b32 v46, 0
    v_mov_b32 v47, 0
    ds_write_b128 v17, v[44:47] offset:8192
    ds_write_b128 v17, v[44:47] offset:9216
    s_waitcnt lgkmcnt(0)
    global_load_dword v16, v18, s[12:13]
    global_load_dwordx4 v[48:51], v17, s[10:11] offset:0
    global_load_dwordx4 v[52:55], v17, s[10:11] offset:1024
    global_load_dwordx4 v[56:59], v17, s[10:11] offset:2048
    global_load_dwordx4 v[60:63], v17, s[10:11] offset:3072
    global_load_dwordx4 v[64:67], v9, s[10:11] offset:0
    global_load_dwordx4 v[68:71], v9, s[10:11] offset:1024
    global_load_dwordx4 v[72:75], v9, s[10:11] offset:2048
    global_load_dwordx4 v[76:79], v9, s[10:11] offset:3072
    global_load_dwordx4 v[80:83], v10, s[10:11] offset:0
    global_load_dwordx4 v[84:87], v10, s[10:11] offset:1024
    global_load_dwordx4 v[88:91], v10, s[10:11] offset:2048
    global_load_dwordx4 v[92:95], v10, s[10:11] offset:3072
    global_load_dwordx4 v[96:99], v11, s[10:11] offset:0
    global_load_dwordx4 v[100:103], v11, s[10:11] offset:1024
    global_load_dwordx4 v[104:107], v11, s[10:11] offset:2048
    global_load_dwordx4 v[108:111], v11, s[10:11] offset:3072
    global_load_dwordx4 v[112:115], v19, s[4:5]
    v_add_u32 v19, 16384, v19
    global_load_dwordx4 v[116:119], v19, s[4:5]
    v_add_u32 v19, 16384, v19
    global_load_dwordx4 v[120:123], v19, s[4:5]
    v_add_u32 v19, 16384, v19
    global_load_dwordx4 v[124:127], v19, s[4:5]
    v_add_u32 v19, 16384, v19
    global_load_dwordx4 v[128:131], v19, s[4:5]
    v_add_u32 v19, 16384, v19
    global_load_dwordx4 v[132:135], v19, s[4:5]
    v_add_u32 v19, 16384, v19
    global_load_dwordx4 v[136:139], v19, s[4:5]
    v_add_u32 v19, 16384, v19
    global_load_dwordx4 v[140:143], v19, s[4:5]
    s_barrier
    s_mov_b32 s91, 0
    s_cmp_lg_u32 s2, 0
    s_cbranch_scc1 L_notag
    s_memrealtime s[92:93]
    s_mov_b64 s[94:95], 0
    s_waitcnt lgkmcnt(0)
    s_lshl_b64 s[92:93], s[92:93], 4
    s_or_b32 s93, s93, 0x80000000
    s_atomic_cmpswap_x2 s[92:95], s[16:17], 0
L_notag:
    s_mov_b32 s28, s18
    s_mov_b32 s29, s19
    s_mov_b32 s30, 9492736
    s_mov_b32 s31, 0x20000
    s_mov_b32 s32, s14
    s_mov_b32 s33, s15
    s_mov_b32 s34, 131072
    s_mov_b32 s35, 0x20000
    s_mul_i32 s90, s36, 593280
    s_mov_b64 s[96:97], 0
    v_mov_b32 v6, 8256
    v_and_b32 v8, 1, v1
    v_mul_u32_u24 v41, 4136, v40
    v_add_u32 v42, 4136, v41
    v_min_u32 v42, 0x10000, v42
    v_add_u32 v43, 0, v40
    v_and_b32 v43, 15, v43
    s_mov_b32 s26, 0
    s_waitcnt vmcnt(24)
    v_min_i32 v21, 4096, v16
    v_max_i32 v22, 0, v21
    v_lshrrev_b32 v23, 4, v22
    v_cmp_lt_i32 vcc, 0, v16
    v_mov_b32 v8, 4096
    s_nop 0
    v_cndmask_b32 v24, v8, v21, vcc
    v_add_u32 v24, 15, v24
    v_lshrrev_b32 v24, 4, v24
    v_mov_b32 v25, v24
    v_min_u32_dpp v23, v23, v23 row_ror:8 row_mask:0xf bank_mask:0xf
    s_nop 0
    v_add_u32_dpp v25, v25, v25 row_ror:8 row_mask:0xf bank_mask:0xf
    v_min_u32_dpp v23, v23, v23 row_ror:4 row_mask:0xf bank_mask:0xf
    s_nop 0
    v_add_u32_dpp v25, v25, v25 row_ror:4 row_mask:0xf bank_mask:0xf
    v_min_u32_dpp v23, v23, v23 row_ror:2 row_mask:0xf bank_mask:0xf
    s_nop 0
    v_add_u32_dpp v25, v25, v25 row_ror:2 row_mask:0xf bank_mask:0xf
    v_min_u32_dpp v23, v23, v23 row_ror:1 row_mask:0xf bank_mask:0xf
    s_nop 0
    v_add_u32_dpp v25, v25, v25 row_ror:1 row_mask:0xf bank_mask:0xf
    v_add_u32 v8, 64256, v17
    s_waitcnt vmcnt(22)
    ds_write_b128 v8, v[48:51] offset:0
    ds_write_b128 v8, v[52:55] offset:1024
    v_xor_b32 v26, v52, v48
    v_xor_b32 v27, v53, v49
    v_xor_b32 v28, v54, v50
    v_xor_b32 v29, v55, v51
    s_waitcnt vmcnt(20)
    ds_write_b128 v8, v[56:59] offset:2048
    ds_write_b128 v8, v[60:63] offset:3072
    v_xor_b32 v12, v56, v48
    v_xor_b32 v13, v60, v48
    v_or3_b32 v26, v26, v12, v13
    v_xor_b32 v12, v57, v49
    v_xor_b32 v13, v61, v49
    v_or3_b32 v27, v27, v12, v13
    v_xor_b32 v12, v58, v50
    v_xor_b32 v13, v62, v50
    v_or3_b32 v28, v28, v12, v13
    v_xor_b32 v12, v59, v51
    v_xor_b32 v13, v63, v51
    v_or3_b32 v29, v29, v12, v13
    s_waitcnt vmcnt(18)
    ds_write_b128 v8, v[64:67] offset:4096
    ds_write_b128 v8, v[68:71] offset:5120
    v_xor_b32 v12, v64, v48
    v_xor_b32 v13, v68, v48
    v_or3_b32 v26, v26, v12, v13
    v_xor_b32 v12, v65, v49
    v_xor_b32 v13, v69, v49
    v_or3_b32 v27, v27, v12, v13
    v_xor_b32 v12, v66, v50
    v_xor_b32 v13, v70, v50
    v_or3_b32 v28, v28, v12, v13
    v_xor_b32 v12, v67, v51
    v_xor_b32 v13, v71, v51
    v_or3_b32 v29, v29, v12, v13
    s_waitcnt vmcnt(16)
    ds_write_b128 v8, v[72:75] offset:6144
    ds_write_b128 v8, v[76:79] offset:7168
    v_xor_b32 v12, v72, v48
    v_xor_b32 v13, v76, v48
    v_or3_b32 v26, v26, v12, v13
    v_xor_b32 v12, v73, v49
    v_xor_b32 v13, v77, v49
    v_or3_b32 v27, v27, v12, v13
    v_xor_b32 v12, v74, v50
    v_xor_b32 v13, v78, v50
    v_or3_b32 v28, v28, v12, v13
    v_xor_b32 v12, v75, v51
    v_xor_b32 v13, v79, v51
    v_or3_b32 v29, v29, v12, v13
    s_waitcnt vmcnt(14)
    ds_write_b128 v8, v[80:83] offset:8192
    ds_write_b128 v8, v[84:87] offset:9216
    v_xor_b32 v12, v80, v48
    v_xor_b32 v13, v84, v48
    v_or3_b32 v26, v26, v12, v13
    v_xor_b32 v12, v81, v49
    v_xor_b32 v13, v85, v49
    v_or3_b32 v27, v27, v12, v13
    v_xor_b32 v12, v82, v50
    v_xor_b32 v13, v86, v50
    v_or3_b32 v28, v28, v12, v13
    v_xor_b32 v12, v83, v51
    v_xor_b32 v13, v87, v51
    v_or3_b32 v29, v29, v12, v13
    s_waitcnt vmcnt(12)
    ds_write_b128 v8, v[88:91] offset:10240
    ds_write_b128 v8, v[92:95] offset:11264
    v_xor_b32 v12, v88, v48
    v_xor_b32 v13, v92, v48
    v_or3_b32 v26, v26, v12, v13
    v_xor_b32 v12, v89, v49
    v_xor_b32 v13, v93, v49
    v_or3_b32 v27, v27, v12, v13
    v_xor_b32 v12, v90, v50
    v_xor_b32 v13, v94, v50
    v_or3_b32 v28, v28, v12, v13
    v_xor_b32 v12, v91, v51
    v_xor_b32 v13, v95, v51
    v_or3_b32 v29, v29, v12, v13
    s_waitcnt vmcnt(10)
    ds_write_b128 v8, v[96:99] offset:12288
    ds_write_b128 v8, v[100:103] offset:13312
    v_xor_b32 v12, v96, v48
    v_xor_b32 v13, v100, v48
    v_or3_b32 v26, v26, v12, v13
    v_xor_b32 v12, v97, v49
    v_xor_b32 v13, v101, v49
    v_or3_b32 v27, v27, v12, v13
    v_xor_b32 v12, v98, v50
    v_xor_b32 v13, v102, v50
    v_or3_b32 v28, v28, v12, v13
    v_xor_b32 v12, v99, v51
    v_xor_b32 v13, v103, v51
    v_or3_b32 v29, v29, v12, v13
    s_waitcnt vmcnt(8)
    ds_write_b128 v8, v[104:107] offset:14336
    ds_write_b128 v8, v[108:111] offset:15360
    v_xor_b32 v12, v104, v48
    v_xor_b32 v13, v108, v48
    v_or3_b32 v26, v26, v12, v13
    v_xor_b32 v12, v105, v49
    v_xor_b32 v13, v109, v49
    v_or3_b32 v27, v27, v12, v13
    v_xor_b32 v12, v106, v50
    v_xor_b32 v13, v110, v50
    v_or3_b32 v28, v28, v12, v13
    v_xor_b32 v12, v107, v51
    v_xor_b32 v13, v111, v51
    v_or3_b32 v29, v29, v12, v13
    v_lshlrev_b32 v12, 2, v1
    v_mov_b32 v13, 256
    v_cmp_ne_u32 vcc, 0, v29
    v_add_u32 v14, 3, v12
    s_nop 0
    v_cndmask_b32 v13, v13, v14, vcc
    v_cmp_ne_u32 vcc, 0, v28
    v_add_u32 v14, 2, v12
    s_nop 0
    v_cndmask_b32 v13, v13, v14, vcc
    v_cmp_ne_u32 vcc, 0, v27
    v_add_u32 v14, 1, v12
    s_nop 0
    v_cndmask_b32 v13, v13, v14, vcc
    v_cmp_ne_u32 vcc, 0, v26
    v_add_u32 v14, 0, v12
    s_nop 0
    v_cndmask_b32 v13, v13, v14, vcc
    v_cmp_gt_u32 vcc, 256, v13
    s_nop 0
    s_ff1_i32_b64 s54, vcc
    s_and_b32 s54, s54, 63
    v_readlane_b32 s55, v13, s54
    v_readfirstlane_b32 s76, v23
    v_readfirstlane_b32 s54, v25
    s_min_u32 s76, s76, s55
    s_mul_i32 s55, s76, 15
    s_sub_u32 s54, s54, s55
    s_mul_i32 s55, s54, 27
    s_lshr_b32 s55, s55, 10
    s_min_u32 s55, s55, 43
    s_add_u32 s56, s76, 15
    s_lshr_b32 s56, s56, 4
    s_max_u32 s55, s55, s56
    s_max_u32 s55, s55, 1
    s_mul_i32 s56, s76, 5
    s_lshr_b32 s56, s56, 6
    s_add_u32 s54, s54, s56
    s_mul_i32 s45, s54, 3
    s_lshr_b32 s45, s45, 6
    v_mul_u32_u24 v41, s54, v41
    v_mul_u32_u24 v42, s54, v42
    v_mul_u32_u24 v44, s55, v43
    v_lshrrev_b32 v41, 16, v41
    v_lshrrev_b32 v42, 16, v42
    v_min_u32 v44, s76, v44
    v_sub_u32 v46, v42, v41
    v_sub_u32 v45, s76, v44
    v_min_u32 v45, s55, v45
    v_subrev_u32 v28, s76, v24
    s_nop 0
    v_readlane_b32 s57, v28, 15
    v_readlane_b32 s50, v22, 15
    v_sub_u32 v47, 14, v40
    v_and_b32 v47, 15, v47
    s_mul_i32 s58, s57, 43
    s_lshr_b32 s58, s58, 9
    s_add_u32 s58, s58, 1
    v_cmp_eq_u32 s[64:65], 15, v40
    v_mul_u32_u24 v47, s58, v47
    v_min_u32 v47, s57, v47
    v_sub_u32 v26, s57, v47
    v_min_u32 v26, s58, v26
    v_cndmask_b32 v28, v28, 0, s[64:65]
    v_sub_u32 v46, v46, v26
    v_sub_u32 v46, v46, v45
    v_mul_u32_u24 v8, 5, v45
    v_lshrrev_b32 v8, 6, v8
    v_sub_u32 v46, v46, v8
    v_max_i32 v46, 0, v46
    v_min_u32 v29, v46, v28
    v_sub_u32 v30, v28, v29
    v_sub_u32 v31, v46, v29
    v_lshl_add_u32 v32, v30, 16, v31
    s_nop 1
    v_add_u32_dpp v32, v32, v32 row_shr:1 row_mask:0xf bank_mask:0xf bound_ctrl:0
    s_nop 1
    v_add_u32_dpp v32, v32, v32 row_shr:2 row_mask:0xf bank_mask:0xf bound_ctrl:0
    s_nop 1
    v_add_u32_dpp v32, v32, v32 row_shr:4 row_mask:0xf bank_mask:0xf bound_ctrl:0
    s_nop 1
    v_add_u32_dpp v32, v32, v32 row_shr:8 row_mask:0xf bank_mask:0xf bound_ctrl:0
    v_and_b32 v33, 0xffff, v32
    v_lshrrev_b32 v34, 16, v32
    v_readlane_b32 s57, v31, 15
    v_cndmask_b32 v33, v33, 0, s[64:65]
    s_nop 0
    v_add_u32 v33, s57, v33
    v_readlane_b32 s48, v47, s37
    v_readlane_b32 s49, v26, s37
    v_sub_u32 v35, v34, v30
    v_sub_u32 v36, v33, v31
    v_readlane_b32 s86, v34, 15
    v_readlane_b32 s83, v44, s37
    v_readlane_b32 s77, v45, s37
    v_min_u32 v36, s86, v36
    v_min_u32 v37, s86, v33
    v_readlane_b32 s54, v29, s37
    v_readlane_b32 s87, v35, s37
    v_readlane_b32 s88, v34, s37
    v_readlane_b32 s81, v22, s37
    v_readlane_b32 s78, v36, s37
    v_readlane_b32 s89, v37, s37
    s_nop 0
    s_sub_u32 s56, s89, s78
    s_add_u32 s51, s77, s49
    s_add_u32 s79, s51, s56
    s_add_u32 s40, s79, s54
    s_sub_u32 s55, s88, s87
    s_add_u32 s80, s76, s55
    s_sub_u32 s80, s80, s79
    v_cmp_gt_u32 vcc, s89, v35
    v_cmp_lt_u32 s[62:63], s78, v34
    v_cmp_lt_u32 s[64:65], 0, v30
    s_and_b32 s84, vcc_lo, s62
    s_and_b32 s84, s84, s64
    s_and_b32 s84, s84, 0xffff
    s_cmp_eq_u32 s56, 0
    s_cselect_b32 s84, 0, s84
    s_lshl_b32 s41, s84, 2
    s_or_b32 s41, s41, 131072
    s_cmp_lg_u32 s49, 0
    s_cselect_b32 s54, 2, 0
    s_or_b32 s41, s41, s54
    s_cmp_lg_u32 s77, 0
    s_cselect_b32 s54, 1, 0
    s_or_b32 s41, s41, s54
    s_ff1_i32_b32 s42, s41
    s_sub_u32 s78, s78, s51
    s_add_u32 s48, s48, s76
    s_sub_u32 s48, s48, s77
    s_waitcnt vmcnt(0)
    ds_write_b128 v17, v[112:115] offset:0
    ds_write_b128 v17, v[116:119] offset:1024
    ds_write_b128 v17, v[120:123] offset:2048
    ds_write_b128 v17, v[124:127] offset:3072
    ds_write_b128 v17, v[128:131] offset:4096
    ds_write_b128 v17, v[132:135] offset:5120
    ds_write_b128 v17, v[136:139] offset:6144
    ds_write_b128 v17, v[140:143] offset:7168
    v_mov_b32 v39, v1
    s_mov_b32 s43, 0
    s_nop 0
L_list:
    v_add_u32 v8, s78, v39
    v_mov_b32 v9, s37
    v_add_u32 v10, s80, v39
    v_mov_b32 v11, 17
    v_mov_b32 v12, s81
    v_cmp_gt_u32 s[62:63], s79, v39
    v_cmp_gt_u32 vcc, s51, v39
    v_cmp_gt_u32 s[64:65], s77, v39
    s_andn2_b64 s[62:63], s[62:63], vcc
    v_subrev_u32 v14, s79, v39
    s_sub_u32 s54, s40, s79
    s_sub_u32 s55, s54, s49
    s_sub_u32 s56, s40, s51
    s_mov_b64 exec, s[62:63]
    v_add_u32 v14, s55, v39
    s_mov_b64 exec, vcc
    v_mov_b32 v9, 15
    v_add_u32 v10, s48, v39
    v_mov_b32 v11, 1
    v_mov_b32 v12, s50
    v_add_u32 v14, s56, v39
    s_mov_b64 exec, s[64:65]
    v_add_u32 v14, s54, v39
    v_mov_b32 v9, 0
    v_add_u32 v10, s83, v39
    v_mov_b32 v11, 0
    v_mov_b32 v12, 4096
    s_mov_b64 exec, -1
    s_mov_b32 s85, s84
L_vl:
    s_cmp_eq_u32 s85, 0
    s_cbranch_scc1 L_vd
    s_ff1_i32_b32 s54, s85
    s_bitset0_b32 s85, s54
    v_readlane_b32 s55, v35, s54
    v_readlane_b32 s56, v22, s54
    s_nop 0
    v_cmp_le_u32 vcc, s55, v8
    s_nop 0
    s_and_b64 exec, vcc, s[62:63]
    s_sub_u32 s55, s76, s55
    s_add_u32 s57, s54, 2
    v_mov_b32 v9, s54
    v_add_u32 v10, s55, v8
    v_mov_b32 v11, s57
    v_mov_b32 v12, s56
    s_mov_b64 exec, -1
    s_branch L_vl
L_vd:
    v_and_b32 v10, 255, v10
    v_lshl_add_u32 v8, v9, 8, v10
    v_lshlrev_b32 v8, 2, v8
    v_add_u32 v8, 64256, v8
    ds_read_b32 v38, v8
    v_lshlrev_b32 v10, 4, v10
    v_sub_u32 v12, v12, v10
    v_med3_i32 v12, v12, 0, 16
    v_lshlrev_b32 v11, 26, v11
    v_lshl_add_u32 v11, v12, 12, v11
    v_lshl_add_u32 v11, v39, 17, v11
    v_cmp_gt_u32 vcc, s40, v39
    v_mov_b32 v13, 0xfc000000
    s_waitcnt lgkmcnt(0)
    v_min_u32 v38, 2175, v38
    v_or_b32 v38, v38, v11
    s_mov_b64 exec, vcc
    v_lshlrev_b32 v8, 2, v14
    ds_write_b32 v8, v38 offset:10240
    v_add_u32 v9, s40, v39
    v_lshlrev_b32 v9, 2, v9
    v_or_b32 v38, 0x80000000, v38
    v_cmp_eq_u32 vcc, 0, v12
    v_or_b32 v10, 0x10000, v38
    s_nop 0
    v_cndmask_b32 v38, v38, v10, vcc
    ds_write_b32 v9, v38 offset:10240
    s_mov_b64 exec, -1
    v_add_u32 v39, 64, v39
    s_add_u32 s43, s43, 64
    s_cmp_lt_u32 s43, s40
    s_cbranch_scc1 L_list
    s_lshl_b32 s56, s40, 3
    v_mov_b32 v8, s56
    ds_write_b32 v8, v13 offset:10240
    v_lshlrev_b32 v8, 2, v1
    ds_read_b32 v10, v8 offset:10240
    s_mov_b32 s57, 131073
    v_mov_b32 v9, s68
    v_mad_u32_u24 v9, v1, s57, v9
    s_waitcnt lgkmcnt(0)
    v_cmp_ne_u32 vcc, v10, v9
    s_mov_b32 s64, 0xffffffff
    s_mov_b32 s65, 0xf
    s_cmp_lt_u32 s40, 36
    s_cselect_b64 vcc, -1, vcc
    s_and_b64 vcc, vcc, s[64:65]
    s_cselect_b32 s54, 0, 0x80000000
    s_cselect_b32 s55, 0, 36
    s_lshl_b32 s56, s40, 19
    s_or_b32 s54, s54, s56
    s_or_b32 s54, s54, s41
    s_mov_b32 s60, 0
    s_and_b32 s58, s36, 3
    s_cmp_eq_u32 s58, 1
    s_cselect_b32 s58, 40, s60
    s_lshl_b32 s59, s40, 1
    s_sub_i32 s59, s59, s58
    s_add_u32 s60, s40, s79
    s_max_i32 s59, s59, s60
    s_mov_b32 s46, s58
    v_mov_b32 v8, s54
    v_mov_b32 v9, s59
    v_mov_b32 v10, 8192
    v_mov_b32 v11, s55
    ds_write_b32 v6, v11
    s_waitcnt lgkmcnt(0)
    ds_write_b64 v10, v[8:9]
    s_bitcmp1_b32 s54, 31
    s_cbranch_scc1 L_hint_ok
    s_waitcnt lgkmcnt(0)
    s_barrier
L_hint_ok:
    v_cmp_lt_u32 vcc, v36, v37
    v_cmp_lt_u32 s[62:63], 0, v45
    s_and_b32 s58, vcc_lo, 0xffff
    s_and_b32 s82, s62, 0xffff
    v_cmp_gt_u32 s[62:63], s88, v36
    v_cmp_lt_u32 s[64:65], s87, v37
    s_and_b32 s58, s58, s62
    s_and_b32 s58, s58, s64
    s_cmp_eq_u32 s87, s88
    s_cselect_b32 s58, 0, s58
    v_cmp_lt_u32 vcc, 0, v26
    s_nop 0
    s_and_b32 s59, vcc_lo, 0xffff
    s_cmp_eq_u32 s37, 15
    s_cselect_b32 s58, s59, s58
    s_lshl_b32 s58, s58, 16
    s_or_b32 s82, s82, s58
    v_and_b32 v16, 0x38, v1
    v_lshlrev_b32 v161, 1, v16
    v_add_u32 v161, 768, v161
    v_mul_u32_u24 v165, 12, v1
    s_mov_b32 s76, 0x07060501
    s_mov_b32 s77, 0x07060502
    s_mov_b32 s78, 0x07060503
    s_mov_b32 s80, 0x04000c0c
    s_mov_b32 s81, 0x0706000c
    v_and_b32 v160, 7, v1
    s_mov_b32 s54, 14336
    v_mad_u32_u24 v160, v160, s54, v161
    s_cmp_lg_u64 s[96:97], 0
    s_cbranch_scc1 L_non_64
    s_load_dwordx2 s[96:97], s[16:17], 0
    s_waitcnt lgkmcnt(0)
    s_cmp_lg_u64 s[96:97], 0
    s_cbranch_scc1 L_non_64
    s_memrealtime s[92:93]
    s_mov_b64 s[94:95], 0
    s_waitcnt lgkmcnt(0)
    s_lshl_b64 s[92:93], s[92:93], 4
    s_or_b32 s93, s93, 0x80000000
    s_mov_b64 s[96:97], s[92:93]
    s_atomic_cmpswap_x2 s[92:95], s[16:17], 0 glc
    s_waitcnt lgkmcnt(0)
    s_cmp_eq_u64 s[92:93], 0
    s_cselect_b64 s[96:97], s[96:97], s[92:93]
L_non_64:
    s_getreg_b32 s98, hwreg(HW_REG_XCC_ID, 0, 4)
    s_or_b32 s98, s98, s96
    s_lshl_b32 s60, s37, 3
    s_add_u32 s61, s90, 458752
    v_mov_b32 v162, s98
    v_mov_b32 v163, s97
    v_mov_b32 v10, s60
    s_mov_b64 exec, 1
    buffer_store_dwordx2 v[162:163], v10, s[28:31], s61 offen
    s_mov_b64 exec, -1
    s_cmp_gt_u32 s45, s40
    s_cbranch_scc1 L_nofb
    s_cmp_lg_u64 s[96:97], 0
    s_cbranch_scc1 L_non_65
    s_load_dwordx2 s[96:97], s[16:17], 0
    s_waitcnt lgkmcnt(0)
    s_cmp_lg_u64 s[96:97], 0
    s_cbranch_scc1 L_non_65
    s_memrealtime s[92:93]
    s_mov_b64 s[94:95], 0
    s_waitcnt lgkmcnt(0)
    s_lshl_b64 s[92:93], s[92:93], 4
    s_or_b32 s93, s93, 0x80000000
    s_mov_b64 s[96:97], s[92:93]
    s_atomic_cmpswap_x2 s[92:95], s[16:17], 0 glc
    s_waitcnt lgkmcnt(0)
    s_cmp_eq_u64 s[92:93], 0
    s_cselect_b64 s[96:97], s[96:97], s[92:93]
L_non_65:
L_wc_66:
    ds_read_b32 v9, v6
    s_waitcnt lgkmcnt(0)
    v_readfirstlane_b32 s54, v9
    s_nop 0
    s_cmp_ge_u32 s54, s45
    s_nop 1
    s_cbranch_scc1 L_wc_67
    s_sleep 3
    s_branch L_wc_66
L_wc_67:
    s_memrealtime s[92:93]
    s_mov_b32 s61, 9492480
    s_waitcnt lgkmcnt(0)
    s_cmp_lg_u32 s37, 7
    s_cbranch_scc1 L_fb1
    v_mov_b32 v12, s96
    v_mov_b32 v13, s97
    v_mov_b32 v14, s92
    v_mov_b32 v15, 0
    s_lshl_b32 s60, s36, 4
    v_mov_b32 v10, s60
    s_mov_b64 exec, 1
    buffer_store_dwordx4 v[12:15], v10, s[28:31], s61 offen sc1
    s_mov_b64 exec, -1
    s_nop 0
L_fb1:
L_wc_68:
    ds_read_b32 v9, v6
    s_waitcnt lgkmcnt(0)
    v_readfirstlane_b32 s54, v9
    s_nop 0
    s_cmp_ge_u32 s54, s40
    s_nop 1
    s_cbranch_scc1 L_wc_69
    s_sleep 3
    s_branch L_wc_68
L_wc_69:
    v_and_b32 v10, 15, v1
    v_lshlrev_b32 v10, 4, v10
    buffer_load_dwordx4 v[12:15], v10, s[28:31], s61 offen
    s_waitcnt vmcnt(0)
    v_cmp_eq_u64 vcc, s[96:97], v[12:13]
    s_nop 0
    s_cmp_lg_u64 vcc, -1
    s_nop 1
    s_cbranch_scc1 L_nofb
    v_sub_u32 v14, s92, v14
    s_nop 1
    v_add_u32_dpp v14, v14, v14 row_ror:8 row_mask:0xf bank_mask:0xf
    s_nop 1
    v_add_u32_dpp v14, v14, v14 row_ror:4 row_mask:0xf bank_mask:0xf
    s_nop 1
    v_add_u32_dpp v14, v14, v14 row_ror:2 row_mask:0xf bank_mask:0xf
    s_nop 1
    v_add_u32_dpp v14, v14, v14 row_ror:1 row_mask:0xf bank_mask:0xf
    s_nop 0
    v_readfirstlane_b32 s54, v14
    s_nop 0
    s_add_i32 s54, s54, 0
    s_mul_i32 s54, s54, 32
    s_ashr_i32 s54, s54, 10
    s_add_i32 s54, s54, s46
    s_max_i32 s54, s54, 0
    s_lshl_b32 s59, s40, 1
    s_sub_i32 s59, s59, s54
    s_add_u32 s60, s40, s79
    s_max_i32 s59, s59, s60
    v_mov_b32 v10, 8192
    v_mov_b32 v11, s59
    ds_write_b32 v10, v11 offset:4
    s_nop 0
L_nofb:
    s_cmp_eq_u32 s42, 17
    s_cbranch_scc1 L_sv_ext
L_wc_70:
    ds_read_b32 v9, v6
    s_waitcnt lgkmcnt(0)
    v_readfirstlane_b32 s54, v9
    s_nop 0
    s_cmp_ge_u32 s54, s40
    s_nop 1
    s_cbranch_scc1 L_wc_71
    s_sleep 3
    s_branch L_wc_70
L_wc_71:
    s_cmp_lg_u64 s[96:97], 0
    s_cbranch_scc1 L_non_72
    s_load_dwordx2 s[96:97], s[16:17], 0
    s_waitcnt lgkmcnt(0)
    s_cmp_lg_u64 s[96:97], 0
    s_cbranch_scc1 L_non_72
    s_memrealtime s[92:93]
    s_mov_b64 s[94:95], 0
    s_waitcnt lgkmcnt(0)
    s_lshl_b64 s[92:93], s[92:93], 4
    s_or_b32 s93, s93, 0x80000000
    s_mov_b64 s[96:97], s[92:93]
    s_atomic_cmpswap_x2 s[92:95], s[16:17], 0 glc
    s_waitcnt lgkmcnt(0)
    s_cmp_eq_u64 s[92:93], 0
    s_cselect_b64 s[96:97], s[96:97], s[92:93]
L_non_72:
    s_cmp_lg_u32 s91, 0
    s_cbranch_scc1 L_loc_73
    s_add_u32 s61, s90, 458752
    v_and_b32 v10, 15, v1
    v_lshlrev_b32 v10, 3, v10
    buffer_load_dwordx2 v[12:13], v10, s[28:31], s61 offen sc1
    s_waitcnt vmcnt(0)
    v_cmp_ne_u64 vcc, v[12:13], v[162:163]
    s_nop 0
    s_cmp_eq_u64 vcc, 0
    s_cselect_b32 s91, 1, 0
    s_nop 1
L_loc_73:
    s_cmp_lg_u32 s42, 0
    s_cbranch_scc1 L_sv_priv
    s_lshl_b32 s54, s42, 2
    s_add_u32 s54, s54, 8320
    v_mov_b32 v8, s54
    s_nop 1
L_ws_74:
    ds_read_b32 v9, v8
    s_waitcnt lgkmcnt(0)
    v_readfirstlane_b32 s54, v9
    s_nop 0
    s_cmp_ge_u32 s54, 3
    s_nop 1
    s_cbranch_scc1 L_ws_75
    s_sleep 4
    s_branch L_ws_74
L_ws_75:
    s_cmp_lg_u64 s[96:97], 0
    s_cbranch_scc1 L_non_76
    s_load_dwordx2 s[96:97], s[16:17], 0
    s_waitcnt lgkmcnt(0)
    s_cmp_lg_u64 s[96:97], 0
    s_cbranch_scc1 L_non_76
    s_memrealtime s[92:93]
    s_mov_b64 s[94:95], 0
    s_waitcnt lgkmcnt(0)
    s_lshl_b64 s[92:93], s[92:93], 4
    s_or_b32 s93, s93, 0x80000000
    s_mov_b64 s[96:97], s[92:93]
    s_atomic_cmpswap_x2 s[92:95], s[16:17], 0 glc
    s_waitcnt lgkmcnt(0)
    s_cmp_eq_u64 s[92:93], 0
    s_cselect_b64 s[96:97], s[96:97], s[92:93]
L_non_76:
    s_cmp_lg_u32 s91, 0
    s_cbranch_scc1 L_loc_77
    s_add_u32 s61, s90, 458752
    v_and_b32 v10, 15, v1
    v_lshlrev_b32 v10, 3, v10
    buffer_load_dwordx2 v[12:13], v10, s[28:31], s61 offen sc1
    s_waitcnt vmcnt(0)
    v_cmp_ne_u64 vcc, v[12:13], v[162:163]
    s_nop 0
    s_cmp_eq_u64 vcc, 0
    s_cselect_b32 s91, 1, 0
    s_nop 1
L_loc_77:
    v_mov_b32 v154, s96
    v_mov_b32 v155, s97
    v_mov_b32 v158, s96
    v_mov_b32 v159, s97
    v_and_b32 v14, 8, v1
    v_lshlrev_b32 v14, 2, v14
    v_xor_b32 v14, v14, v17
    v_add_u32 v8, 64256, v14
    v_xor_b32 v14, 64, v8
    v_add_u32 v9, 113408, v16
    s_mul_i32 s54, s37, 896
    s_add_u32 s54, s54, s90
    s_mov_b32 s56, s54
    s_mov_b32 s62, 0x01010101
    s_mov_b32 s63, 0x01010101
    ds_read_b128 v[24:27], v8 offset:0
    ds_read_b64 v[28:29], v9 offset:0
    ds_read_b128 v[32:35], v8 offset:16384
    ds_read_b64 v[36:37], v9 offset:1024
    ds_read_b128 v[40:43], v8 offset:32768
    ds_read_b64 v[44:45], v9 offset:2048
    ds_read_b128 v[48:51], v14 offset:1024
    ds_read_b64 v[52:53], v9 offset:64
    ds_read_b128 v[56:59], v14 offset:17408
    ds_read_b64 v[60:61], v9 offset:1088
    ds_read_b128 v[64:67], v14 offset:33792
    ds_read_b64 v[68:69], v9 offset:2112
    s_waitcnt lgkmcnt(6)
    v_mov_b32 v10, v28
    v_max_f32 v10, v10, v36
    v_max_f32 v10, v10, v44
    v_sub_f32 v28, v28, v10
    v_sub_f32 v36, v36, v10
    v_sub_f32 v44, v44, v10
    v_exp_f32 v28, v28
    v_exp_f32 v36, v36
    v_exp_f32 v44, v44
    v_mov_b32 v18, v10
    v_mul_f32 v19, v29, v28
    v_mul_f32 v88, v24, v28
    v_mul_f32 v89, v25, v28
    v_mul_f32 v90, v26, v28
    v_mul_f32 v91, v27, v28
    v_fmac_f32 v19, v37, v36
    v_fmac_f32 v88, v32, v36
    v_fmac_f32 v89, v33, v36
    v_fmac_f32 v90, v34, v36
    v_fmac_f32 v91, v35, v36
    v_fmac_f32 v19, v45, v44
    v_fmac_f32 v88, v40, v44
    v_fmac_f32 v89, v41, v44
    v_fmac_f32 v90, v42, v44
    v_fmac_f32 v91, v43, v44
    v_perm_b32 v88, v88, v91, s76
    v_perm_b32 v89, v89, v91, s77
    v_perm_b32 v90, v90, v91, s78
    s_cmp_lg_u32 s91, 0
    s_cbranch_scc1 L_tw_78
    buffer_store_dwordx3 v[88:90], v165, s[28:31], s54 offen sc1 nt
    s_nop 0
    s_branch L_tw_79
L_tw_78:
    buffer_store_dwordx3 v[88:90], v165, s[28:31], s54 offen
    s_nop 1
L_tw_79:
    s_add_u32 s54, s54, 14336
    s_mov_b64 exec, s[62:63]
    v_mov_b32 v152, v18
    v_mov_b32 v153, v19
    s_mov_b64 exec, -1
    s_lshl_b64 s[62:63], s[62:63], 1
    ds_read_b128 v[24:27], v8 offset:2048
    ds_read_b64 v[28:29], v9 offset:128
    ds_read_b128 v[32:35], v8 offset:18432
    ds_read_b64 v[36:37], v9 offset:1152
    ds_read_b128 v[40:43], v8 offset:34816
    ds_read_b64 v[44:45], v9 offset:2176
    s_waitcnt lgkmcnt(6)
    v_mov_b32 v10, v52
    v_max_f32 v10, v10, v60
    v_max_f32 v10, v10, v68
    v_sub_f32 v52, v52, v10
    v_sub_f32 v60, v60, v10
    v_sub_f32 v68, v68, v10
    v_exp_f32 v52, v52
    v_exp_f32 v60, v60
    v_exp_f32 v68, v68
    v_mov_b32 v18, v10
    v_mul_f32 v19, v53, v52
    v_mul_f32 v92, v48, v52
    v_mul_f32 v93, v49, v52
    v_mul_f32 v94, v50, v52
    v_mul_f32 v95, v51, v52
    v_fmac_f32 v19, v61, v60
    v_fmac_f32 v92, v56, v60
    v_fmac_f32 v93, v57, v60
    v_fmac_f32 v94, v58, v60
    v_fmac_f32 v95, v59, v60
    v_fmac_f32 v19, v69, v68
    v_fmac_f32 v92, v64, v68
    v_fmac_f32 v93, v65, v68
    v_fmac_f32 v94, v66, v68
    v_fmac_f32 v95, v67, v68
    v_perm_b32 v92, v92, v95, s76
    v_perm_b32 v93, v93, v95, s77
    v_perm_b32 v94, v94, v95, s78
    s_cmp_lg_u32 s91, 0
    s_cbranch_scc1 L_tw_80
    buffer_store_dwordx3 v[92:94], v165, s[28:31], s54 offen sc1 nt
    s_nop 0
    s_branch L_tw_81
L_tw_80:
    buffer_store_dwordx3 v[92:94], v165, s[28:31], s54 offen
    s_nop 1
L_tw_81:
    s_add_u32 s54, s54, 14336
    s_mov_b64 exec, s[62:63]
    v_mov_b32 v152, v18
    v_mov_b32 v153, v19
    s_mov_b64 exec, -1
    s_lshl_b64 s[62:63], s[62:63], 1
    ds_read_b128 v[48:51], v14 offset:3072
    ds_read_b64 v[52:53], v9 offset:192
    ds_read_b128 v[56:59], v14 offset:19456
    ds_read_b64 v[60:61], v9 offset:1216
    ds_read_b128 v[64:67], v14 offset:35840
    ds_read_b64 v[68:69], v9 offset:2240
    s_waitcnt lgkmcnt(6)
    v_mov_b32 v10, v28
    v_max_f32 v10, v10, v36
    v_max_f32 v10, v10, v44
    v_sub_f32 v28, v28, v10
    v_sub_f32 v36, v36, v10
    v_sub_f32 v44, v44, v10
    v_exp_f32 v28, v28
    v_exp_f32 v36, v36
    v_exp_f32 v44, v44
    v_mov_b32 v18, v10
    v_mul_f32 v19, v29, v28
    v_mul_f32 v96, v24, v28
    v_mul_f32 v97, v25, v28
    v_mul_f32 v98, v26, v28
    v_mul_f32 v99, v27, v28
    v_fmac_f32 v19, v37, v36
    v_fmac_f32 v96, v32, v36
    v_fmac_f32 v97, v33, v36
    v_fmac_f32 v98, v34, v36
    v_fmac_f32 v99, v35, v36
    v_fmac_f32 v19, v45, v44
    v_fmac_f32 v96, v40, v44
    v_fmac_f32 v97, v41, v44
    v_fmac_f32 v98, v42, v44
    v_fmac_f32 v99, v43, v44
    v_perm_b32 v96, v96, v99, s76
    v_perm_b32 v97, v97, v99, s77
    v_perm_b32 v98, v98, v99, s78
    s_cmp_lg_u32 s91, 0
    s_cbranch_scc1 L_tw_82
    buffer_store_dwordx3 v[96:98], v165, s[28:31], s54 offen sc1 nt
    s_nop 0
    s_branch L_tw_83
L_tw_82:
    buffer_store_dwordx3 v[96:98], v165, s[28:31], s54 offen
    s_nop 1
L_tw_83:
    s_add_u32 s54, s54, 14336
    s_mov_b64 exec, s[62:63]
    v_mov_b32 v152, v18
    v_mov_b32 v153, v19
    s_mov_b64 exec, -1
    s_lshl_b64 s[62:63], s[62:63], 1
    ds_read_b128 v[24:27], v8 offset:4096
    ds_read_b64 v[28:29], v9 offset:256
    ds_read_b128 v[32:35], v8 offset:20480
    ds_read_b64 v[36:37], v9 offset:1280
    ds_read_b128 v[40:43], v8 offset:36864
    ds_read_b64 v[44:45], v9 offset:2304
    s_waitcnt lgkmcnt(6)
    v_mov_b32 v10, v52
    v_max_f32 v10, v10, v60
    v_max_f32 v10, v10, v68
    v_sub_f32 v52, v52, v10
    v_sub_f32 v60, v60, v10
    v_sub_f32 v68, v68, v10
    v_exp_f32 v52, v52
    v_exp_f32 v60, v60
    v_exp_f32 v68, v68
    v_mov_b32 v18, v10
    v_mul_f32 v19, v53, v52
    v_mul_f32 v100, v48, v52
    v_mul_f32 v101, v49, v52
    v_mul_f32 v102, v50, v52
    v_mul_f32 v103, v51, v52
    v_fmac_f32 v19, v61, v60
    v_fmac_f32 v100, v56, v60
    v_fmac_f32 v101, v57, v60
    v_fmac_f32 v102, v58, v60
    v_fmac_f32 v103, v59, v60
    v_fmac_f32 v19, v69, v68
    v_fmac_f32 v100, v64, v68
    v_fmac_f32 v101, v65, v68
    v_fmac_f32 v102, v66, v68
    v_fmac_f32 v103, v67, v68
    v_perm_b32 v100, v100, v103, s76
    v_perm_b32 v101, v101, v103, s77
    v_perm_b32 v102, v102, v103, s78
    s_cmp_lg_u32 s91, 0
    s_cbranch_scc1 L_tw_84
    buffer_store_dwordx3 v[100:102], v165, s[28:31], s54 offen sc1 nt
    s_nop 0
    s_branch L_tw_85
L_tw_84:
    buffer_store_dwordx3 v[100:102], v165, s[28:31], s54 offen
    s_nop 1
L_tw_85:
    s_add_u32 s54, s54, 14336
    s_mov_b64 exec, s[62:63]
    v_mov_b32 v152, v18
    v_mov_b32 v153, v19
    s_mov_b64 exec, -1
    s_lshl_b64 s[62:63], s[62:63], 1
    ds_read_b128 v[48:51], v14 offset:5120
    ds_read_b64 v[52:53], v9 offset:320
    ds_read_b128 v[56:59], v14 offset:21504
    ds_read_b64 v[60:61], v9 offset:1344
    ds_read_b128 v[64:67], v14 offset:37888
    ds_read_b64 v[68:69], v9 offset:2368
    s_waitcnt lgkmcnt(6)
    v_mov_b32 v10, v28
    v_max_f32 v10, v10, v36
    v_max_f32 v10, v10, v44
    v_sub_f32 v28, v28, v10
    v_sub_f32 v36, v36, v10
    v_sub_f32 v44, v44, v10
    v_exp_f32 v28, v28
    v_exp_f32 v36, v36
    v_exp_f32 v44, v44
    v_mov_b32 v18, v10
    v_mul_f32 v19, v29, v28
    v_mul_f32 v104, v24, v28
    v_mul_f32 v105, v25, v28
    v_mul_f32 v106, v26, v28
    v_mul_f32 v107, v27, v28
    v_fmac_f32 v19, v37, v36
    v_fmac_f32 v104, v32, v36
    v_fmac_f32 v105, v33, v36
    v_fmac_f32 v106, v34, v36
    v_fmac_f32 v107, v35, v36
    v_fmac_f32 v19, v45, v44
    v_fmac_f32 v104, v40, v44
    v_fmac_f32 v105, v41, v44
    v_fmac_f32 v106, v42, v44
    v_fmac_f32 v107, v43, v44
    v_perm_b32 v104, v104, v107, s76
    v_perm_b32 v105, v105, v107, s77
    v_perm_b32 v106, v106, v107, s78
    s_cmp_lg_u32 s91, 0
    s_cbranch_scc1 L_tw_86
    buffer_store_dwordx3 v[104:106], v165, s[28:31], s54 offen sc1 nt
    s_nop 0
    s_branch L_tw_87
L_tw_86:
    buffer_store_dwordx3 v[104:106], v165, s[28:31], s54 offen
    s_nop 1
L_tw_87:
    s_add_u32 s54, s54, 14336
    s_mov_b64 exec, s[62:63]
    v_mov_b32 v152, v18
    v_mov_b32 v153, v19
    s_mov_b64 exec, -1
    s_lshl_b64 s[62:63], s[62:63], 1
    ds_read_b128 v[24:27], v8 offset:6144
    ds_read_b64 v[28:29], v9 offset:384
    ds_read_b128 v[32:35], v8 offset:22528
    ds_read_b64 v[36:37], v9 offset:1408
    ds_read_b128 v[40:43], v8 offset:38912
    ds_read_b64 v[44:45], v9 offset:2432
    s_waitcnt lgkmcnt(6)
    v_mov_b32 v10, v52
    v_max_f32 v10, v10, v60
    v_max_f32 v10, v10, v68
    v_sub_f32 v52, v52, v10
    v_sub_f32 v60, v60, v10
    v_sub_f32 v68, v68, v10
    v_exp_f32 v52, v52
    v_exp_f32 v60, v60
    v_exp_f32 v68, v68
    v_mov_b32 v18, v10
    v_mul_f32 v19, v53, v52
    v_mul_f32 v108, v48, v52
    v_mul_f32 v109, v49, v52
    v_mul_f32 v110, v50, v52
    v_mul_f32 v111, v51, v52
    v_fmac_f32 v19, v61, v60
    v_fmac_f32 v108, v56, v60
    v_fmac_f32 v109, v57, v60
    v_fmac_f32 v110, v58, v60
    v_fmac_f32 v111, v59, v60
    v_fmac_f32 v19, v69, v68
    v_fmac_f32 v108, v64, v68
    v_fmac_f32 v109, v65, v68
    v_fmac_f32 v110, v66, v68
    v_fmac_f32 v111, v67, v68
    v_perm_b32 v108, v108, v111, s76
    v_perm_b32 v109, v109, v111, s77
    v_perm_b32 v110, v110, v111, s78
    s_cmp_lg_u32 s91, 0
    s_cbranch_scc1 L_tw_88
    buffer_store_dwordx3 v[108:110], v165, s[28:31], s54 offen sc1 nt
    s_nop 0
    s_branch L_tw_89
L_tw_88:
    buffer_store_dwordx3 v[108:110], v165, s[28:31], s54 offen
    s_nop 1
L_tw_89:
    s_add_u32 s54, s54, 14336
    s_mov_b64 exec, s[62:63]
    v_mov_b32 v152, v18
    v_mov_b32 v153, v19
    s_mov_b64 exec, -1
    s_lshl_b64 s[62:63], s[62:63], 1
    ds_read_b128 v[48:51], v14 offset:7168
    ds_read_b64 v[52:53], v9 offset:448
    ds_read_b128 v[56:59], v14 offset:23552
    ds_read_b64 v[60:61], v9 offset:1472
    ds_read_b128 v[64:67], v14 offset:39936
    ds_read_b64 v[68:69], v9 offset:2496
    s_waitcnt lgkmcnt(6)
    v_mov_b32 v10, v28
    v_max_f32 v10, v10, v36
    v_max_f32 v10, v10, v44
    v_sub_f32 v28, v28, v10
    v_sub_f32 v36, v36, v10
    v_sub_f32 v44, v44, v10
    v_exp_f32 v28, v28
    v_exp_f32 v36, v36
    v_exp_f32 v44, v44
    v_mov_b32 v18, v10
    v_mul_f32 v19, v29, v28
    v_mul_f32 v112, v24, v28
    v_mul_f32 v113, v25, v28
    v_mul_f32 v114, v26, v28
    v_mul_f32 v115, v27, v28
    v_fmac_f32 v19, v37, v36
    v_fmac_f32 v112, v32, v36
    v_fmac_f32 v113, v33, v36
    v_fmac_f32 v114, v34, v36
    v_fmac_f32 v115, v35, v36
    v_fmac_f32 v19, v45, v44
    v_fmac_f32 v112, v40, v44
    v_fmac_f32 v113, v41, v44
    v_fmac_f32 v114, v42, v44
    v_fmac_f32 v115, v43, v44
    v_perm_b32 v112, v112, v115, s76
    v_perm_b32 v113, v113, v115, s77
    v_perm_b32 v114, v114, v115, s78
    s_cmp_lg_u32 s91, 0
    s_cbranch_scc1 L_tw_90
    buffer_store_dwordx3 v[112:114], v165, s[28:31], s54 offen sc1 nt
    s_nop 0
    s_branch L_tw_91
L_tw_90:
    buffer_store_dwordx3 v[112:114], v165, s[28:31], s54 offen
    s_nop 1
L_tw_91:
    s_add_u32 s54, s54, 14336
    s_mov_b64 exec, s[62:63]
    v_mov_b32 v152, v18
    v_mov_b32 v153, v19
    s_mov_b64 exec, -1
    s_lshl_b64 s[62:63], s[62:63], 1
    ds_read_b128 v[24:27], v8 offset:8192
    ds_read_b64 v[28:29], v9 offset:512
    ds_read_b128 v[32:35], v8 offset:24576
    ds_read_b64 v[36:37], v9 offset:1536
    ds_read_b128 v[40:43], v8 offset:40960
    ds_read_b64 v[44:45], v9 offset:2560
    s_waitcnt lgkmcnt(6)
    v_mov_b32 v10, v52
    v_max_f32 v10, v10, v60
    v_max_f32 v10, v10, v68
    v_sub_f32 v52, v52, v10
    v_sub_f32 v60, v60, v10
    v_sub_f32 v68, v68, v10
    v_exp_f32 v52, v52
    v_exp_f32 v60, v60
    v_exp_f32 v68, v68
    v_mov_b32 v18, v10
    v_mul_f32 v19, v53, v52
    v_mul_f32 v116, v48, v52
    v_mul_f32 v117, v49, v52
    v_mul_f32 v118, v50, v52
    v_mul_f32 v119, v51, v52
    v_fmac_f32 v19, v61, v60
    v_fmac_f32 v116, v56, v60
    v_fmac_f32 v117, v57, v60
    v_fmac_f32 v118, v58, v60
    v_fmac_f32 v119, v59, v60
    v_fmac_f32 v19, v69, v68
    v_fmac_f32 v116, v64, v68
    v_fmac_f32 v117, v65, v68
    v_fmac_f32 v118, v66, v68
    v_fmac_f32 v119, v67, v68
    v_perm_b32 v116, v116, v119, s76
    v_perm_b32 v117, v117, v119, s77
    v_perm_b32 v118, v118, v119, s78
    s_cmp_lg_u32 s91, 0
    s_cbranch_scc1 L_tw_92
    buffer_store_dwordx3 v[116:118], v165, s[28:31], s54 offen sc1 nt
    s_nop 0
    s_branch L_tw_93
L_tw_92:
    buffer_store_dwordx3 v[116:118], v165, s[28:31], s54 offen
    s_nop 1
L_tw_93:
    s_add_u32 s54, s54, 14336
    s_mov_b64 exec, s[62:63]
    v_mov_b32 v152, v18
    v_mov_b32 v153, v19
    s_mov_b64 exec, -1
    s_lshl_b64 s[62:63], s[62:63], 1
    s_mov_b32 s62, 0x01010101
    s_mov_b32 s63, 0x01010101
    ds_read_b128 v[48:51], v14 offset:9216
    ds_read_b64 v[52:53], v9 offset:576
    ds_read_b128 v[56:59], v14 offset:25600
    ds_read_b64 v[60:61], v9 offset:1600
    ds_read_b128 v[64:67], v14 offset:41984
    ds_read_b64 v[68:69], v9 offset:2624
    s_waitcnt lgkmcnt(6)
    v_mov_b32 v10, v28
    v_max_f32 v10, v10, v36
    v_max_f32 v10, v10, v44
    v_sub_f32 v28, v28, v10
    v_sub_f32 v36, v36, v10
    v_sub_f32 v44, v44, v10
    v_exp_f32 v28, v28
    v_exp_f32 v36, v36
    v_exp_f32 v44, v44
    v_mov_b32 v18, v10
    v_mul_f32 v19, v29, v28
    v_mul_f32 v120, v24, v28
    v_mul_f32 v121, v25, v28
    v_mul_f32 v122, v26, v28
    v_mul_f32 v123, v27, v28
    v_fmac_f32 v19, v37, v36
    v_fmac_f32 v120, v32, v36
    v_fmac_f32 v121, v33, v36
    v_fmac_f32 v122, v34, v36
    v_fmac_f32 v123, v35, v36
    v_fmac_f32 v19, v45, v44
    v_fmac_f32 v120, v40, v44
    v_fmac_f32 v121, v41, v44
    v_fmac_f32 v122, v42, v44
    v_fmac_f32 v123, v43, v44
    v_perm_b32 v120, v120, v123, s76
    v_perm_b32 v121, v121, v123, s77
    v_perm_b32 v122, v122, v123, s78
    s_cmp_lg_u32 s91, 0
    s_cbranch_scc1 L_tw_94
    buffer_store_dwordx3 v[120:122], v165, s[28:31], s54 offen sc1 nt
    s_nop 0
    s_branch L_tw_95
L_tw_94:
    buffer_store_dwordx3 v[120:122], v165, s[28:31], s54 offen
    s_nop 1
L_tw_95:
    s_add_u32 s54, s54, 14336
    s_mov_b64 exec, s[62:63]
    v_mov_b32 v156, v18
    v_mov_b32 v157, v19
    s_mov_b64 exec, -1
    s_lshl_b64 s[62:63], s[62:63], 1
    ds_read_b128 v[24:27], v8 offset:10240
    ds_read_b64 v[28:29], v9 offset:640
    ds_read_b128 v[32:35], v8 offset:26624
    ds_read_b64 v[36:37], v9 offset:1664
    ds_read_b128 v[40:43], v8 offset:43008
    ds_read_b64 v[44:45], v9 offset:2688
    s_waitcnt lgkmcnt(6)
    v_mov_b32 v10, v52
    v_max_f32 v10, v10, v60
    v_max_f32 v10, v10, v68
    v_sub_f32 v52, v52, v10
    v_sub_f32 v60, v60, v10
    v_sub_f32 v68, v68, v10
    v_exp_f32 v52, v52
    v_exp_f32 v60, v60
    v_exp_f32 v68, v68
    v_mov_b32 v18, v10
    v_mul_f32 v19, v53, v52
    v_mul_f32 v124, v48, v52
    v_mul_f32 v125, v49, v52
    v_mul_f32 v126, v50, v52
    v_mul_f32 v127, v51, v52
    v_fmac_f32 v19, v61, v60
    v_fmac_f32 v124, v56, v60
    v_fmac_f32 v125, v57, v60
    v_fmac_f32 v126, v58, v60
    v_fmac_f32 v127, v59, v60
    v_fmac_f32 v19, v69, v68
    v_fmac_f32 v124, v64, v68
    v_fmac_f32 v125, v65, v68
    v_fmac_f32 v126, v66, v68
    v_fmac_f32 v127, v67, v68
    v_perm_b32 v124, v124, v127, s76
    v_perm_b32 v125, v125, v127, s77
    v_perm_b32 v126, v126, v127, s78
    s_cmp_lg_u32 s91, 0
    s_cbranch_scc1 L_tw_96
    buffer_store_dwordx3 v[124:126], v165, s[28:31], s54 offen sc1 nt
    s_nop 0
    s_branch L_tw_97
L_tw_96:
    buffer_store_dwordx3 v[124:126], v165, s[28:31], s54 offen
    s_nop 1
L_tw_97:
    s_add_u32 s54, s54, 14336
    s_mov_b64 exec, s[62:63]
    v_mov_b32 v156, v18
    v_mov_b32 v157, v19
    s_mov_b64 exec, -1
    s_lshl_b64 s[62:63], s[62:63], 1
    ds_read_b128 v[48:51], v14 offset:11264
    ds_read_b64 v[52:53], v9 offset:704
    ds_read_b128 v[56:59], v14 offset:27648
    ds_read_b64 v[60:61], v9 offset:1728
    ds_read_b128 v[64:67], v14 offset:44032
    ds_read_b64 v[68:69], v9 offset:2752
    s_waitcnt lgkmcnt(6)
    v_mov_b32 v10, v28
    v_max_f32 v10, v10, v36
    v_max_f32 v10, v10, v44
    v_sub_f32 v28, v28, v10
    v_sub_f32 v36, v36, v10
    v_sub_f32 v44, v44, v10
    v_exp_f32 v28, v28
    v_exp_f32 v36, v36
    v_exp_f32 v44, v44
    v_mov_b32 v18, v10
    v_mul_f32 v19, v29, v28
    v_mul_f32 v128, v24, v28
    v_mul_f32 v129, v25, v28
    v_mul_f32 v130, v26, v28
    v_mul_f32 v131, v27, v28
    v_fmac_f32 v19, v37, v36
    v_fmac_f32 v128, v32, v36
    v_fmac_f32 v129, v33, v36
    v_fmac_f32 v130, v34, v36
    v_fmac_f32 v131, v35, v36
    v_fmac_f32 v19, v45, v44
    v_fmac_f32 v128, v40, v44
    v_fmac_f32 v129, v41, v44
    v_fmac_f32 v130, v42, v44
    v_fmac_f32 v131, v43, v44
    v_perm_b32 v128, v128, v131, s76
    v_perm_b32 v129, v129, v131, s77
    v_perm_b32 v130, v130, v131, s78
    s_cmp_lg_u32 s91, 0
    s_cbranch_scc1 L_tw_98
    buffer_store_dwordx3 v[128:130], v165, s[28:31], s54 offen sc1 nt
    s_nop 0
    s_branch L_tw_99
L_tw_98:
    buffer_store_dwordx3 v[128:130], v165, s[28:31], s54 offen
    s_nop 1
L_tw_99:
    s_add_u32 s54, s54, 14336
    s_mov_b64 exec, s[62:63]
    v_mov_b32 v156, v18
    v_mov_b32 v157, v19
    s_mov_b64 exec, -1
    s_lshl_b64 s[62:63], s[62:63], 1
    ds_read_b128 v[24:27], v8 offset:12288
    ds_read_b64 v[28:29], v9 offset:768
    ds_read_b128 v[32:35], v8 offset:28672
    ds_read_b64 v[36:37], v9 offset:1792
    ds_read_b128 v[40:43], v8 offset:45056
    ds_read_b64 v[44:45], v9 offset:2816
    s_waitcnt lgkmcnt(6)
    v_mov_b32 v10, v52
    v_max_f32 v10, v10, v60
    v_max_f32 v10, v10, v68
    v_sub_f32 v52, v52, v10
    v_sub_f32 v60, v60, v10
    v_sub_f32 v68, v68, v10
    v_exp_f32 v52, v52
    v_exp_f32 v60, v60
    v_exp_f32 v68, v68
    v_mov_b32 v18, v10
    v_mul_f32 v19, v53, v52
    v_mul_f32 v132, v48, v52
    v_mul_f32 v133, v49, v52
    v_mul_f32 v134, v50, v52
    v_mul_f32 v135, v51, v52
    v_fmac_f32 v19, v61, v60
    v_fmac_f32 v132, v56, v60
    v_fmac_f32 v133, v57, v60
    v_fmac_f32 v134, v58, v60
    v_fmac_f32 v135, v59, v60
    v_fmac_f32 v19, v69, v68
    v_fmac_f32 v132, v64, v68
    v_fmac_f32 v133, v65, v68
    v_fmac_f32 v134, v66, v68
    v_fmac_f32 v135, v67, v68
    v_perm_b32 v132, v132, v135, s76
    v_perm_b32 v133, v133, v135, s77
    v_perm_b32 v134, v134, v135, s78
    s_cmp_lg_u32 s91, 0
    s_cbranch_scc1 L_tw_100
    buffer_store_dwordx3 v[132:134], v165, s[28:31], s54 offen sc1 nt
    s_nop 0
    s_branch L_tw_101
L_tw_100:
    buffer_store_dwordx3 v[132:134], v165, s[28:31], s54 offen
    s_nop 1
L_tw_101:
    s_add_u32 s54, s54, 14336
    s_mov_b64 exec, s[62:63]
    v_mov_b32 v156, v18
    v_mov_b32 v157, v19
    s_mov_b64 exec, -1
    s_lshl_b64 s[62:63], s[62:63], 1
    ds_read_b128 v[48:51], v14 offset:13312
    ds_read_b64 v[52:53], v9 offset:832
    ds_read_b128 v[56:59], v14 offset:29696
    ds_read_b64 v[60:61], v9 offset:1856
    ds_read_b128 v[64:67], v14 offset:46080
    ds_read_b64 v[68:69], v9 offset:2880
    s_waitcnt lgkmcnt(6)
    v_mov_b32 v10, v28
    v_max_f32 v10, v10, v36
    v_max_f32 v10, v10, v44
    v_sub_f32 v28, v28, v10
    v_sub_f32 v36, v36, v10
    v_sub_f32 v44, v44, v10
    v_exp_f32 v28, v28
    v_exp_f32 v36, v36
    v_exp_f32 v44, v44
    v_mov_b32 v18, v10
    v_mul_f32 v19, v29, v28
    v_mul_f32 v136, v24, v28
    v_mul_f32 v137, v25, v28
    v_mul_f32 v138, v26, v28
    v_mul_f32 v139, v27, v28
    v_fmac_f32 v19, v37, v36
    v_fmac_f32 v136, v32, v36
    v_fmac_f32 v137, v33, v36
    v_fmac_f32 v138, v34, v36
    v_fmac_f32 v139, v35, v36
    v_fmac_f32 v19, v45, v44
    v_fmac_f32 v136, v40, v44
    v_fmac_f32 v137, v41, v44
    v_fmac_f32 v138, v42, v44
    v_fmac_f32 v139, v43, v44
    v_perm_b32 v136, v136, v139, s76
    v_perm_b32 v137, v137, v139, s77
    v_perm_b32 v138, v138, v139, s78
    s_cmp_lg_u32 s91, 0
    s_cbranch_scc1 L_tw_102
    buffer_store_dwordx3 v[136:138], v165, s[28:31], s54 offen sc1 nt
    s_nop 0
    s_branch L_tw_103
L_tw_102:
    buffer_store_dwordx3 v[136:138], v165, s[28:31], s54 offen
    s_nop 1
L_tw_103:
    s_add_u32 s54, s54, 14336
    s_mov_b64 exec, s[62:63]
    v_mov_b32 v156, v18
    v_mov_b32 v157, v19
    s_mov_b64 exec, -1
    s_lshl_b64 s[62:63], s[62:63], 1
    ds_read_b128 v[24:27], v8 offset:14336
    ds_read_b64 v[28:29], v9 offset:896
    ds_read_b128 v[32:35], v8 offset:30720
    ds_read_b64 v[36:37], v9 offset:1920
    ds_read_b128 v[40:43], v8 offset:47104
    ds_read_b64 v[44:45], v9 offset:2944
    s_waitcnt lgkmcnt(6)
    v_mov_b32 v10, v52
    v_max_f32 v10, v10, v60
    v_max_f32 v10, v10, v68
    v_sub_f32 v52, v52, v10
    v_sub_f32 v60, v60, v10
    v_sub_f32 v68, v68, v10
    v_exp_f32 v52, v52
    v_exp_f32 v60, v60
    v_exp_f32 v68, v68
    v_mov_b32 v18, v10
    v_mul_f32 v19, v53, v52
    v_mul_f32 v140, v48, v52
    v_mul_f32 v141, v49, v52
    v_mul_f32 v142, v50, v52
    v_mul_f32 v143, v51, v52
    v_fmac_f32 v19, v61, v60
    v_fmac_f32 v140, v56, v60
    v_fmac_f32 v141, v57, v60
    v_fmac_f32 v142, v58, v60
    v_fmac_f32 v143, v59, v60
    v_fmac_f32 v19, v69, v68
    v_fmac_f32 v140, v64, v68
    v_fmac_f32 v141, v65, v68
    v_fmac_f32 v142, v66, v68
    v_fmac_f32 v143, v67, v68
    v_perm_b32 v140, v140, v143, s76
    v_perm_b32 v141, v141, v143, s77
    v_perm_b32 v142, v142, v143, s78
    s_cmp_lg_u32 s91, 0
    s_cbranch_scc1 L_tw_104
    buffer_store_dwordx3 v[140:142], v165, s[28:31], s54 offen sc1 nt
    s_nop 0
    s_branch L_tw_105
L_tw_104:
    buffer_store_dwordx3 v[140:142], v165, s[28:31], s54 offen
    s_nop 1
L_tw_105:
    s_add_u32 s54, s54, 14336
    s_mov_b64 exec, s[62:63]
    v_mov_b32 v156, v18
    v_mov_b32 v157, v19
    s_mov_b64 exec, -1
    s_lshl_b64 s[62:63], s[62:63], 1
    ds_read_b128 v[48:51], v14 offset:15360
    ds_read_b64 v[52:53], v9 offset:960
    ds_read_b128 v[56:59], v14 offset:31744
    ds_read_b64 v[60:61], v9 offset:1984
    ds_read_b128 v[64:67], v14 offset:48128
    ds_read_b64 v[68:69], v9 offset:3008
    s_waitcnt lgkmcnt(6)
    v_mov_b32 v10, v28
    v_max_f32 v10, v10, v36
    v_max_f32 v10, v10, v44
    v_sub_f32 v28, v28, v10
    v_sub_f32 v36, v36, v10
    v_sub_f32 v44, v44, v10
    v_exp_f32 v28, v28
    v_exp_f32 v36, v36
    v_exp_f32 v44, v44
    v_mov_b32 v18, v10
    v_mul_f32 v19, v29, v28
    v_mul_f32 v144, v24, v28
    v_mul_f32 v145, v25, v28
    v_mul_f32 v146, v26, v28
    v_mul_f32 v147, v27, v28
    v_fmac_f32 v19, v37, v36
    v_fmac_f32 v144, v32, v36
    v_fmac_f32 v145, v33, v36
    v_fmac_f32 v146, v34, v36
    v_fmac_f32 v147, v35, v36
    v_fmac_f32 v19, v45, v44
    v_fmac_f32 v144, v40, v44
    v_fmac_f32 v145, v41, v44
    v_fmac_f32 v146, v42, v44
    v_fmac_f32 v147, v43, v44
    v_perm_b32 v144, v144, v147, s76
    v_perm_b32 v145, v145, v147, s77
    v_perm_b32 v146, v146, v147, s78
    s_cmp_lg_u32 s91, 0
    s_cbranch_scc1 L_tw_106
    buffer_store_dwordx3 v[144:146], v165, s[28:31], s54 offen sc1 nt
    s_nop 0
    s_branch L_tw_107
L_tw_106:
    buffer_store_dwordx3 v[144:146], v165, s[28:31], s54 offen
    s_nop 1
L_tw_107:
    s_add_u32 s54, s54, 14336
    s_mov_b64 exec, s[62:63]
    v_mov_b32 v156, v18
    v_mov_b32 v157, v19
    s_mov_b64 exec, -1
    s_lshl_b64 s[62:63], s[62:63], 1
    s_waitcnt lgkmcnt(0)
    v_mov_b32 v10, v52
    v_max_f32 v10, v10, v60
    v_max_f32 v10, v10, v68
    v_sub_f32 v52, v52, v10
    v_sub_f32 v60, v60, v10
    v_sub_f32 v68, v68, v10
    v_exp_f32 v52, v52
    v_exp_f32 v60, v60
    v_exp_f32 v68, v68
    v_mov_b32 v18, v10
    v_mul_f32 v19, v53, v52
    v_mul_f32 v148, v48, v52
    v_mul_f32 v149, v49, v52
    v_mul_f32 v150, v50, v52
    v_mul_f32 v151, v51, v52
    v_fmac_f32 v19, v61, v60
    v_fmac_f32 v148, v56, v60
    v_fmac_f32 v149, v57, v60
    v_fmac_f32 v150, v58, v60
    v_fmac_f32 v151, v59, v60
    v_fmac_f32 v19, v69, v68
    v_fmac_f32 v148, v64, v68
    v_fmac_f32 v149, v65, v68
    v_fmac_f32 v150, v66, v68
    v_fmac_f32 v151, v67, v68
    v_perm_b32 v148, v148, v151, s76
    v_perm_b32 v149, v149, v151, s77
    v_perm_b32 v150, v150, v151, s78
    s_cmp_lg_u32 s91, 0
    s_cbranch_scc1 L_tw_108
    buffer_store_dwordx3 v[148:150], v165, s[28:31], s54 offen sc1 nt
    s_nop 0
    s_branch L_tw_109
L_tw_108:
    buffer_store_dwordx3 v[148:150], v165, s[28:31], s54 offen
    s_nop 1
L_tw_109:
    s_add_u32 s54, s54, 14336
    s_mov_b64 exec, s[62:63]
    v_mov_b32 v156, v18
    v_mov_b32 v157, v19
    s_mov_b64 exec, -1
    s_lshl_b64 s[62:63], s[62:63], 1
    s_add_u32 s57, s56, 114688
    s_cmp_lg_u32 s91, 0
    s_cbranch_scc1 L_tw_110
    s_waitcnt vmcnt(0)
    buffer_store_dwordx4 v[152:155], v160, s[28:31], s56 offen sc1 nt
    buffer_store_dwordx4 v[156:159], v160, s[28:31], s57 offen sc1 nt
    s_nop 0
    s_branch L_tw_111
L_tw_110:
    s_waitcnt vmcnt(0)
    buffer_store_dwordx4 v[152:155], v160, s[28:31], s56 offen
    buffer_store_dwordx4 v[156:159], v160, s[28:31], s57 offen
    s_nop 1
L_tw_111:
    s_bitset0_b32 s41, 0
    s_ff1_i32_b32 s42, s41
L_sv_next:
    s_cmp_eq_u32 s42, 17
    s_cbranch_scc1 L_sv_ext
L_sv_priv:
    s_lshl_b32 s54, s42, 2
    s_add_u32 s54, s54, 8320
    v_mov_b32 v8, s54
    s_nop 1
L_ws_112:
    ds_read_b32 v9, v8
    s_waitcnt lgkmcnt(0)
    v_readfirstlane_b32 s54, v9
    s_nop 0
    s_cmp_ge_u32 s54, 3
    s_nop 1
    s_cbranch_scc1 L_ws_113
    s_sleep 4
    s_branch L_ws_112
L_ws_113:
    s_cmp_lg_u64 s[96:97], 0
    s_cbranch_scc1 L_non_114
    s_load_dwordx2 s[96:97], s[16:17], 0
    s_waitcnt lgkmcnt(0)
    s_cmp_lg_u64 s[96:97], 0
    s_cbranch_scc1 L_non_114
    s_memrealtime s[92:93]
    s_mov_b64 s[94:95], 0
    s_waitcnt lgkmcnt(0)
    s_lshl_b64 s[92:93], s[92:93], 4
    s_or_b32 s93, s93, 0x80000000
    s_mov_b64 s[96:97], s[92:93]
    s_atomic_cmpswap_x2 s[92:95], s[16:17], 0 glc
    s_waitcnt lgkmcnt(0)
    s_cmp_eq_u64 s[92:93], 0
    s_cselect_b64 s[96:97], s[96:97], s[92:93]
L_non_114:
    s_cmp_lg_u32 s91, 0
    s_cbranch_scc1 L_loc_115
    s_add_u32 s61, s90, 458752
    v_and_b32 v10, 15, v1
    v_lshlrev_b32 v10, 3, v10
    buffer_load_dwordx2 v[12:13], v10, s[28:31], s61 offen sc1
    s_waitcnt vmcnt(0)
    v_cmp_ne_u64 vcc, v[12:13], v[162:163]
    s_nop 0
    s_cmp_eq_u64 vcc, 0
    s_cselect_b32 s91, 1, 0
    s_nop 1
L_loc_115:
    s_and_b32 s56, s26, 3
    s_cmp_eq_u32 s42, 17
    s_cselect_b32 s56, 4, s56
    s_mul_i32 s56, s56, 3264
    s_add_u32 s56, s56, 12400
    v_add_u32 v8, s56, v17
    v_add_u32 v9, s56, v16
    ds_read_b128 v[24:27], v8 offset:0
    ds_read_b64 v[28:29], v9 offset:1024
    ds_read_b128 v[32:35], v8 offset:1088
    ds_read_b64 v[36:37], v9 offset:2112
    ds_read_b128 v[40:43], v8 offset:2176
    ds_read_b64 v[44:45], v9 offset:3200
    s_sub_u32 s54, s42, 2
    s_and_b32 s54, s54, 15
    s_add_u32 s54, s54, 16
    s_lshl_b32 s54, s54, 4
    s_add_u32 s54, s54, s37
    s_mul_i32 s54, s54, 896
    s_add_u32 s54, s54, s90
    s_add_u32 s26, s26, 1
    v_mov_b32 v12, s26
    s_waitcnt vmcnt(0) lgkmcnt(0)
    ds_write_b32 v6, v12 offset:4
    v_mov_b32 v10, v28
    v_max_f32 v10, v10, v36
    v_max_f32 v10, v10, v44
    v_sub_f32 v28, v28, v10
    v_sub_f32 v36, v36, v10
    v_sub_f32 v44, v44, v10
    v_exp_f32 v28, v28
    v_exp_f32 v36, v36
    v_exp_f32 v44, v44
    v_mov_b32 v18, v10
    v_mul_f32 v19, v29, v28
    v_mul_f32 v20, v24, v28
    v_mul_f32 v21, v25, v28
    v_mul_f32 v22, v26, v28
    v_mul_f32 v23, v27, v28
    v_fmac_f32 v19, v37, v36
    v_fmac_f32 v20, v32, v36
    v_fmac_f32 v21, v33, v36
    v_fmac_f32 v22, v34, v36
    v_fmac_f32 v23, v35, v36
    v_fmac_f32 v19, v45, v44
    v_fmac_f32 v20, v40, v44
    v_fmac_f32 v21, v41, v44
    v_fmac_f32 v22, v42, v44
    v_fmac_f32 v23, v43, v44
    v_mov_b32 v154, s96
    v_mov_b32 v155, s97
    v_mov_b32 v158, s96
    v_mov_b32 v159, s97
    v_mov_b32 v152, v18
    v_mov_b32 v153, v19
    v_perm_b32 v20, v20, v23, s76
    v_perm_b32 v21, v21, v23, s77
    v_perm_b32 v22, v22, v23, s78
    s_cmp_lg_u32 s91, 0
    s_cbranch_scc1 L_tw_116
    buffer_store_dwordx3 v[20:22], v165, s[28:31], s54 offen sc1 nt
    s_waitcnt vmcnt(0)
    s_mov_b32 exec_lo, 0x01010101
    s_mov_b32 exec_hi, 0x01010101
    buffer_store_dwordx4 v[152:155], v160, s[28:31], s54 offen sc1 nt
    s_mov_b64 exec, -1
    s_branch L_tw_117
L_tw_116:
    buffer_store_dwordx3 v[20:22], v165, s[28:31], s54 offen
    s_waitcnt vmcnt(0)
    s_mov_b32 exec_lo, 0x01010101
    s_mov_b32 exec_hi, 0x01010101
    buffer_store_dwordx4 v[152:155], v160, s[28:31], s54 offen
    s_mov_b64 exec, -1
    s_nop 0
L_tw_117:
    s_bitset0_b32 s41, s42
    s_ff1_i32_b32 s42, s41
    s_branch L_sv_next
L_sv_ext:
    v_mov_b32 v18, 0xf149f2ca
    v_mov_b32 v19, 0
    v_mov_b32 v20, 0
    v_mov_b32 v21, 0
    v_mov_b32 v22, 0
    v_mov_b32 v23, 0
    s_cmp_eq_u32 s82, 0
    s_cbranch_scc1 L_sv_final
    s_lshl_b32 s56, s40, 1
    s_sub_i32 s56, s56, 34
L_sv_near:
    ds_read_b32 v9, v6
    s_waitcnt lgkmcnt(0)
    v_readfirstlane_b32 s54, v9
    s_nop 0
    s_cmp_ge_i32 s54, s56
    s_nop 1
    s_cbranch_scc1 L_sv_near_done
    s_sleep 8
    s_branch L_sv_near
L_sv_near_done:
    s_cmp_lg_u64 s[96:97], 0
    s_cbranch_scc1 L_non_118
    s_load_dwordx2 s[96:97], s[16:17], 0
    s_waitcnt lgkmcnt(0)
    s_cmp_lg_u64 s[96:97], 0
    s_cbranch_scc1 L_non_118
    s_memrealtime s[92:93]
    s_mov_b64 s[94:95], 0
    s_waitcnt lgkmcnt(0)
    s_lshl_b64 s[92:93], s[92:93], 4
    s_or_b32 s93, s93, 0x80000000
    s_mov_b64 s[96:97], s[92:93]
    s_atomic_cmpswap_x2 s[92:95], s[16:17], 0 glc
    s_waitcnt lgkmcnt(0)
    s_cmp_eq_u64 s[92:93], 0
    s_cselect_b64 s[96:97], s[96:97], s[92:93]
L_non_118:
L_sv_batch:
    s_lshl_b32 s57, s37, 4
    v_mov_b32 v152, 0xf149f2ca
    v_mov_b32 v153, 0
    v_mov_b32 v156, 0xf149f2ca
    v_mov_b32 v157, 0
    v_mov_b32 v8, 0
    v_mov_b32 v164, 0
    s_mov_b64 s[64:65], 0
    s_mov_b64 s[68:69], 0
    s_mov_b32 s58, 0
    s_mov_b32 s62, 0x01010101
    s_mov_b32 s63, 0x01010101
    s_ff1_i32_b32 s54, s82
    s_bitset0_b32 s82, s54
    s_and_b32 s55, s54, 15
    s_lshr_b32 s56, s54, 4
    s_lshl_b32 s56, s56, 8
    s_add_u32 s55, s55, s56
    s_add_u32 s55, s55, s57
    s_mul_i32 s55, s55, 896
    s_add_u32 s55, s55, s90
    s_mov_b64 exec, s[62:63]
    v_add_u32 v8, s55, v161
    s_mov_b64 exec, -1
    s_or_b64 s[64:65], s[64:65], s[62:63]
    s_lshl_b64 s[62:63], s[62:63], 1
    s_mov_b32 s58, 1
    s_cmp_eq_u32 s82, 0
    s_cbranch_scc1 L_sv_slots
    s_ff1_i32_b32 s54, s82
    s_bitset0_b32 s82, s54
    s_and_b32 s55, s54, 15
    s_lshr_b32 s56, s54, 4
    s_lshl_b32 s56, s56, 8
    s_add_u32 s55, s55, s56
    s_add_u32 s55, s55, s57
    s_mul_i32 s55, s55, 896
    s_add_u32 s55, s55, s90
    s_mov_b64 exec, s[62:63]
    v_add_u32 v8, s55, v161
    s_mov_b64 exec, -1
    s_or_b64 s[64:65], s[64:65], s[62:63]
    s_lshl_b64 s[62:63], s[62:63], 1
    s_mov_b32 s58, 2
    s_cmp_eq_u32 s82, 0
    s_cbranch_scc1 L_sv_slots
    s_ff1_i32_b32 s54, s82
    s_bitset0_b32 s82, s54
    s_and_b32 s55, s54, 15
    s_lshr_b32 s56, s54, 4
    s_lshl_b32 s56, s56, 8
    s_add_u32 s55, s55, s56
    s_add_u32 s55, s55, s57
    s_mul_i32 s55, s55, 896
    s_add_u32 s55, s55, s90
    s_mov_b64 exec, s[62:63]
    v_add_u32 v8, s55, v161
    s_mov_b64 exec, -1
    s_or_b64 s[64:65], s[64:65], s[62:63]
    s_lshl_b64 s[62:63], s[62:63], 1
    s_mov_b32 s58, 3
    s_cmp_eq_u32 s82, 0
    s_cbranch_scc1 L_sv_slots
    s_ff1_i32_b32 s54, s82
    s_bitset0_b32 s82, s54
    s_and_b32 s55, s54, 15
    s_lshr_b32 s56, s54, 4
    s_lshl_b32 s56, s56, 8
    s_add_u32 s55, s55, s56
    s_add_u32 s55, s55, s57
    s_mul_i32 s55, s55, 896
    s_add_u32 s55, s55, s90
    s_mov_b64 exec, s[62:63]
    v_add_u32 v8, s55, v161
    s_mov_b64 exec, -1
    s_or_b64 s[64:65], s[64:65], s[62:63]
    s_lshl_b64 s[62:63], s[62:63], 1
    s_mov_b32 s58, 4
    s_cmp_eq_u32 s82, 0
    s_cbranch_scc1 L_sv_slots
    s_ff1_i32_b32 s54, s82
    s_bitset0_b32 s82, s54
    s_and_b32 s55, s54, 15
    s_lshr_b32 s56, s54, 4
    s_lshl_b32 s56, s56, 8
    s_add_u32 s55, s55, s56
    s_add_u32 s55, s55, s57
    s_mul_i32 s55, s55, 896
    s_add_u32 s55, s55, s90
    s_mov_b64 exec, s[62:63]
    v_add_u32 v8, s55, v161
    s_mov_b64 exec, -1
    s_or_b64 s[64:65], s[64:65], s[62:63]
    s_lshl_b64 s[62:63], s[62:63], 1
    s_mov_b32 s58, 5
    s_cmp_eq_u32 s82, 0
    s_cbranch_scc1 L_sv_slots
    s_ff1_i32_b32 s54, s82
    s_bitset0_b32 s82, s54
    s_and_b32 s55, s54, 15
    s_lshr_b32 s56, s54, 4
    s_lshl_b32 s56, s56, 8
    s_add_u32 s55, s55, s56
    s_add_u32 s55, s55, s57
    s_mul_i32 s55, s55, 896
    s_add_u32 s55, s55, s90
    s_mov_b64 exec, s[62:63]
    v_add_u32 v8, s55, v161
    s_mov_b64 exec, -1
    s_or_b64 s[64:65], s[64:65], s[62:63]
    s_lshl_b64 s[62:63], s[62:63], 1
    s_mov_b32 s58, 6
    s_cmp_eq_u32 s82, 0
    s_cbranch_scc1 L_sv_slots
    s_ff1_i32_b32 s54, s82
    s_bitset0_b32 s82, s54
    s_and_b32 s55, s54, 15
    s_lshr_b32 s56, s54, 4
    s_lshl_b32 s56, s56, 8
    s_add_u32 s55, s55, s56
    s_add_u32 s55, s55, s57
    s_mul_i32 s55, s55, 896
    s_add_u32 s55, s55, s90
    s_mov_b64 exec, s[62:63]
    v_add_u32 v8, s55, v161
    s_mov_b64 exec, -1
    s_or_b64 s[64:65], s[64:65], s[62:63]
    s_lshl_b64 s[62:63], s[62:63], 1
    s_mov_b32 s58, 7
    s_cmp_eq_u32 s82, 0
    s_cbranch_scc1 L_sv_slots
    s_ff1_i32_b32 s54, s82
    s_bitset0_b32 s82, s54
    s_and_b32 s55, s54, 15
    s_lshr_b32 s56, s54, 4
    s_lshl_b32 s56, s56, 8
    s_add_u32 s55, s55, s56
    s_add_u32 s55, s55, s57
    s_mul_i32 s55, s55, 896
    s_add_u32 s55, s55, s90
    s_mov_b64 exec, s[62:63]
    v_add_u32 v8, s55, v161
    s_mov_b64 exec, -1
    s_or_b64 s[64:65], s[64:65], s[62:63]
    s_lshl_b64 s[62:63], s[62:63], 1
    s_mov_b32 s58, 8
    s_mov_b32 s62, 0x01010101
    s_mov_b32 s63, 0x01010101
    s_cmp_eq_u32 s82, 0
    s_cbranch_scc1 L_sv_slots
    s_ff1_i32_b32 s54, s82
    s_bitset0_b32 s82, s54
    s_and_b32 s55, s54, 15
    s_lshr_b32 s56, s54, 4
    s_lshl_b32 s56, s56, 8
    s_add_u32 s55, s55, s56
    s_add_u32 s55, s55, s57
    s_mul_i32 s55, s55, 896
    s_add_u32 s55, s55, s90
    s_mov_b64 exec, s[62:63]
    v_add_u32 v164, s55, v161
    s_mov_b64 exec, -1
    s_or_b64 s[68:69], s[68:69], s[62:63]
    s_lshl_b64 s[62:63], s[62:63], 1
    s_mov_b32 s58, 9
    s_cmp_eq_u32 s82, 0
    s_cbranch_scc1 L_sv_slots
    s_ff1_i32_b32 s54, s82
    s_bitset0_b32 s82, s54
    s_and_b32 s55, s54, 15
    s_lshr_b32 s56, s54, 4
    s_lshl_b32 s56, s56, 8
    s_add_u32 s55, s55, s56
    s_add_u32 s55, s55, s57
    s_mul_i32 s55, s55, 896
    s_add_u32 s55, s55, s90
    s_mov_b64 exec, s[62:63]
    v_add_u32 v164, s55, v161
    s_mov_b64 exec, -1
    s_or_b64 s[68:69], s[68:69], s[62:63]
    s_lshl_b64 s[62:63], s[62:63], 1
    s_mov_b32 s58, 10
    s_cmp_eq_u32 s82, 0
    s_cbranch_scc1 L_sv_slots
    s_ff1_i32_b32 s54, s82
    s_bitset0_b32 s82, s54
    s_and_b32 s55, s54, 15
    s_lshr_b32 s56, s54, 4
    s_lshl_b32 s56, s56, 8
    s_add_u32 s55, s55, s56
    s_add_u32 s55, s55, s57
    s_mul_i32 s55, s55, 896
    s_add_u32 s55, s55, s90
    s_mov_b64 exec, s[62:63]
    v_add_u32 v164, s55, v161
    s_mov_b64 exec, -1
    s_or_b64 s[68:69], s[68:69], s[62:63]
    s_lshl_b64 s[62:63], s[62:63], 1
    s_mov_b32 s58, 11
    s_cmp_eq_u32 s82, 0
    s_cbranch_scc1 L_sv_slots
    s_ff1_i32_b32 s54, s82
    s_bitset0_b32 s82, s54
    s_and_b32 s55, s54, 15
    s_lshr_b32 s56, s54, 4
    s_lshl_b32 s56, s56, 8
    s_add_u32 s55, s55, s56
    s_add_u32 s55, s55, s57
    s_mul_i32 s55, s55, 896
    s_add_u32 s55, s55, s90
    s_mov_b64 exec, s[62:63]
    v_add_u32 v164, s55, v161
    s_mov_b64 exec, -1
    s_or_b64 s[68:69], s[68:69], s[62:63]
    s_lshl_b64 s[62:63], s[62:63], 1
    s_mov_b32 s58, 12
    s_cmp_eq_u32 s82, 0
    s_cbranch_scc1 L_sv_slots
    s_ff1_i32_b32 s54, s82
    s_bitset0_b32 s82, s54
    s_and_b32 s55, s54, 15
    s_lshr_b32 s56, s54, 4
    s_lshl_b32 s56, s56, 8
    s_add_u32 s55, s55, s56
    s_add_u32 s55, s55, s57
    s_mul_i32 s55, s55, 896
    s_add_u32 s55, s55, s90
    s_mov_b64 exec, s[62:63]
    v_add_u32 v164, s55, v161
    s_mov_b64 exec, -1
    s_or_b64 s[68:69], s[68:69], s[62:63]
    s_lshl_b64 s[62:63], s[62:63], 1
    s_mov_b32 s58, 13
    s_cmp_eq_u32 s82, 0
    s_cbranch_scc1 L_sv_slots
    s_ff1_i32_b32 s54, s82
    s_bitset0_b32 s82, s54
    s_and_b32 s55, s54, 15
    s_lshr_b32 s56, s54, 4
    s_lshl_b32 s56, s56, 8
    s_add_u32 s55, s55, s56
    s_add_u32 s55, s55, s57
    s_mul_i32 s55, s55, 896
    s_add_u32 s55, s55, s90
    s_mov_b64 exec, s[62:63]
    v_add_u32 v164, s55, v161
    s_mov_b64 exec, -1
    s_or_b64 s[68:69], s[68:69], s[62:63]
    s_lshl_b64 s[62:63], s[62:63], 1
    s_mov_b32 s58, 14
    s_cmp_eq_u32 s82, 0
    s_cbranch_scc1 L_sv_slots
    s_ff1_i32_b32 s54, s82
    s_bitset0_b32 s82, s54
    s_and_b32 s55, s54, 15
    s_lshr_b32 s56, s54, 4
    s_lshl_b32 s56, s56, 8
    s_add_u32 s55, s55, s56
    s_add_u32 s55, s55, s57
    s_mul_i32 s55, s55, 896
    s_add_u32 s55, s55, s90
    s_mov_b64 exec, s[62:63]
    v_add_u32 v164, s55, v161
    s_mov_b64 exec, -1
    s_or_b64 s[68:69], s[68:69], s[62:63]
    s_lshl_b64 s[62:63], s[62:63], 1
    s_mov_b32 s58, 15
    s_cmp_eq_u32 s82, 0
    s_cbranch_scc1 L_sv_slots
    s_ff1_i32_b32 s54, s82
    s_bitset0_b32 s82, s54
    s_and_b32 s55, s54, 15
    s_lshr_b32 s56, s54, 4
    s_lshl_b32 s56, s56, 8
    s_add_u32 s55, s55, s56
    s_add_u32 s55, s55, s57
    s_mul_i32 s55, s55, 896
    s_add_u32 s55, s55, s90
    s_mov_b64 exec, s[62:63]
    v_add_u32 v164, s55, v161
    s_mov_b64 exec, -1
    s_or_b64 s[68:69], s[68:69], s[62:63]
    s_lshl_b64 s[62:63], s[62:63], 1
    s_mov_b32 s58, 16
L_sv_slots:
    s_mov_b32 s55, 0
L_sv_poll:
    s_mov_b64 exec, s[64:65]
    buffer_load_dwordx4 v[152:155], v8, s[28:31], 0 offen sc1 nt
    s_cmp_le_u32 s58, 8
    s_cbranch_scc1 L_sv_poll1
    s_mov_b64 exec, s[68:69]
    buffer_load_dwordx4 v[156:159], v164, s[28:31], 0 offen sc1 nt
L_sv_poll1:
    s_mov_b64 exec, -1
    v_mov_b32 v32, 0
    v_mov_b32 v33, 0
    v_mov_b32 v34, 0
    v_mov_b32 v35, 0
    v_mov_b32 v40, 0
    v_mov_b32 v41, 0
    v_mov_b32 v42, 0
    v_mov_b32 v43, 0
    v_mov_b32 v48, 0
    v_mov_b32 v49, 0
    v_mov_b32 v50, 0
    v_mov_b32 v51, 0
    v_mov_b32 v56, 0
    v_mov_b32 v57, 0
    v_mov_b32 v58, 0
    v_mov_b32 v59, 0
    v_mov_b32 v64, 0
    v_mov_b32 v65, 0
    v_mov_b32 v66, 0
    v_mov_b32 v67, 0
    v_mov_b32 v72, 0
    v_mov_b32 v73, 0
    v_mov_b32 v74, 0
    v_mov_b32 v75, 0
    v_mov_b32 v80, 0
    v_mov_b32 v81, 0
    v_mov_b32 v82, 0
    v_mov_b32 v83, 0
    v_mov_b32 v88, 0
    v_mov_b32 v89, 0
    v_mov_b32 v90, 0
    v_mov_b32 v91, 0
    v_mov_b32 v96, 0
    v_mov_b32 v97, 0
    v_mov_b32 v98, 0
    v_mov_b32 v99, 0
    v_mov_b32 v104, 0
    v_mov_b32 v105, 0
    v_mov_b32 v106, 0
    v_mov_b32 v107, 0
    v_mov_b32 v112, 0
    v_mov_b32 v113, 0
    v_mov_b32 v114, 0
    v_mov_b32 v115, 0
    v_mov_b32 v120, 0
    v_mov_b32 v121, 0
    v_mov_b32 v122, 0
    v_mov_b32 v123, 0
    v_mov_b32 v128, 0
    v_mov_b32 v129, 0
    v_mov_b32 v130, 0
    v_mov_b32 v131, 0
    v_mov_b32 v136, 0
    v_mov_b32 v137, 0
    v_mov_b32 v138, 0
    v_mov_b32 v139, 0
    v_mov_b32 v144, 0
    v_mov_b32 v145, 0
    v_mov_b32 v146, 0
    v_mov_b32 v147, 0
    s_waitcnt vmcnt(0)
    v_cmp_ne_u64 vcc, s[96:97], v[154:155]
    v_cmp_ne_u64 s[62:63], s[96:97], v[158:159]
    s_and_b64 vcc, vcc, s[64:65]
    s_and_b64 s[62:63], s[62:63], s[68:69]
    s_or_b64 vcc, vcc, s[62:63]
    s_nop 0
    s_cbranch_scc0 L_sv_ready
    s_sleep 8
    s_add_u32 s55, s55, 1
    s_cmp_lt_u32 s55, 1048576
    s_cbranch_scc1 L_sv_poll
L_sv_ready:
    v_readlane_b32 s54, v8, 0
    s_nop 0
    s_sub_u32 s54, s54, 768
    s_nop 2
    buffer_load_dwordx3 v[24:26], v165, s[28:31], s54 offen sc1 nt
    s_cmp_le_u32 s58, 1
    s_cbranch_scc1 L_sv_issued
    v_readlane_b32 s54, v8, 1
    s_nop 0
    s_sub_u32 s54, s54, 768
    s_nop 2
    buffer_load_dwordx3 v[32:34], v165, s[28:31], s54 offen sc1 nt
    s_cmp_le_u32 s58, 2
    s_cbranch_scc1 L_sv_issued
    v_readlane_b32 s54, v8, 2
    s_nop 0
    s_sub_u32 s54, s54, 768
    s_nop 2
    buffer_load_dwordx3 v[40:42], v165, s[28:31], s54 offen sc1 nt
    s_cmp_le_u32 s58, 3
    s_cbranch_scc1 L_sv_issued
    v_readlane_b32 s54, v8, 3
    s_nop 0
    s_sub_u32 s54, s54, 768
    s_nop 2
    buffer_load_dwordx3 v[48:50], v165, s[28:31], s54 offen sc1 nt
    s_cmp_le_u32 s58, 4
    s_cbranch_scc1 L_sv_issued
    v_readlane_b32 s54, v8, 4
    s_nop 0
    s_sub_u32 s54, s54, 768
    s_nop 2
    buffer_load_dwordx3 v[56:58], v165, s[28:31], s54 offen sc1 nt
    s_cmp_le_u32 s58, 5
    s_cbranch_scc1 L_sv_issued
    v_readlane_b32 s54, v8, 5
    s_nop 0
    s_sub_u32 s54, s54, 768
    s_nop 2
    buffer_load_dwordx3 v[64:66], v165, s[28:31], s54 offen sc1 nt
    s_cmp_le_u32 s58, 6
    s_cbranch_scc1 L_sv_issued
    v_readlane_b32 s54, v8, 6
    s_nop 0
    s_sub_u32 s54, s54, 768
    s_nop 2
    buffer_load_dwordx3 v[72:74], v165, s[28:31], s54 offen sc1 nt
    s_cmp_le_u32 s58, 7
    s_cbranch_scc1 L_sv_issued
    v_readlane_b32 s54, v8, 7
    s_nop 0
    s_sub_u32 s54, s54, 768
    s_nop 2
    buffer_load_dwordx3 v[80:82], v165, s[28:31], s54 offen sc1 nt
    s_cmp_le_u32 s58, 8
    s_cbranch_scc1 L_sv_issued
    v_readlane_b32 s54, v164, 0
    s_nop 0
    s_sub_u32 s54, s54, 768
    s_nop 2
    buffer_load_dwordx3 v[88:90], v165, s[28:31], s54 offen sc1 nt
    s_cmp_le_u32 s58, 9
    s_cbranch_scc1 L_sv_issued
    v_readlane_b32 s54, v164, 1
    s_nop 0
    s_sub_u32 s54, s54, 768
    s_nop 2
    buffer_load_dwordx3 v[96:98], v165, s[28:31], s54 offen sc1 nt
    s_cmp_le_u32 s58, 10
    s_cbranch_scc1 L_sv_issued
    v_readlane_b32 s54, v164, 2
    s_nop 0
    s_sub_u32 s54, s54, 768
    s_nop 2
    buffer_load_dwordx3 v[104:106], v165, s[28:31], s54 offen sc1 nt
    s_cmp_le_u32 s58, 11
    s_cbranch_scc1 L_sv_issued
    v_readlane_b32 s54, v164, 3
    s_nop 0
    s_sub_u32 s54, s54, 768
    s_nop 2
    buffer_load_dwordx3 v[112:114], v165, s[28:31], s54 offen sc1 nt
    s_cmp_le_u32 s58, 12
    s_cbranch_scc1 L_sv_issued
    v_readlane_b32 s54, v164, 4
    s_nop 0
    s_sub_u32 s54, s54, 768
    s_nop 2
    buffer_load_dwordx3 v[120:122], v165, s[28:31], s54 offen sc1 nt
    s_cmp_le_u32 s58, 13
    s_cbranch_scc1 L_sv_issued
    v_readlane_b32 s54, v164, 5
    s_nop 0
    s_sub_u32 s54, s54, 768
    s_nop 2
    buffer_load_dwordx3 v[128:130], v165, s[28:31], s54 offen sc1 nt
    s_cmp_le_u32 s58, 14
    s_cbranch_scc1 L_sv_issued
    v_readlane_b32 s54, v164, 6
    s_nop 0
    s_sub_u32 s54, s54, 768
    s_nop 2
    buffer_load_dwordx3 v[136:138], v165, s[28:31], s54 offen sc1 nt
    s_cmp_le_u32 s58, 15
    s_cbranch_scc1 L_sv_issued
    v_readlane_b32 s54, v164, 7
    s_nop 0
    s_sub_u32 s54, s54, 768
    s_nop 2
    buffer_load_dwordx3 v[144:146], v165, s[28:31], s54 offen sc1 nt
L_sv_issued:
    ds_swizzle_b32 v28, v152 offset:0x18
    ds_swizzle_b32 v29, v153 offset:0x18
    ds_swizzle_b32 v36, v152 offset:0x38
    ds_swizzle_b32 v37, v153 offset:0x38
    ds_swizzle_b32 v44, v152 offset:0x58
    ds_swizzle_b32 v45, v153 offset:0x58
    ds_swizzle_b32 v52, v152 offset:0x78
    ds_swizzle_b32 v53, v153 offset:0x78
    ds_swizzle_b32 v60, v152 offset:0x98
    ds_swizzle_b32 v61, v153 offset:0x98
    ds_swizzle_b32 v68, v152 offset:0xb8
    ds_swizzle_b32 v69, v153 offset:0xb8
    ds_swizzle_b32 v76, v152 offset:0xd8
    ds_swizzle_b32 v77, v153 offset:0xd8
    ds_swizzle_b32 v84, v152 offset:0xf8
    ds_swizzle_b32 v85, v153 offset:0xf8
    ds_swizzle_b32 v92, v156 offset:0x18
    ds_swizzle_b32 v93, v157 offset:0x18
    ds_swizzle_b32 v100, v156 offset:0x38
    ds_swizzle_b32 v101, v157 offset:0x38
    ds_swizzle_b32 v108, v156 offset:0x58
    ds_swizzle_b32 v109, v157 offset:0x58
    ds_swizzle_b32 v116, v156 offset:0x78
    ds_swizzle_b32 v117, v157 offset:0x78
    ds_swizzle_b32 v124, v156 offset:0x98
    ds_swizzle_b32 v125, v157 offset:0x98
    ds_swizzle_b32 v132, v156 offset:0xb8
    ds_swizzle_b32 v133, v157 offset:0xb8
    ds_swizzle_b32 v140, v156 offset:0xd8
    ds_swizzle_b32 v141, v157 offset:0xd8
    ds_swizzle_b32 v148, v156 offset:0xf8
    ds_swizzle_b32 v149, v157 offset:0xf8
    s_waitcnt vmcnt(0) lgkmcnt(0)
    v_perm_b32 v27, v26, v25, s80
    v_perm_b32 v27, v27, v24, s81
    v_perm_b32 v35, v34, v33, s80
    v_perm_b32 v35, v35, v32, s81
    v_perm_b32 v43, v42, v41, s80
    v_perm_b32 v43, v43, v40, s81
    v_perm_b32 v51, v50, v49, s80
    v_perm_b32 v51, v51, v48, s81
    v_perm_b32 v59, v58, v57, s80
    v_perm_b32 v59, v59, v56, s81
    v_perm_b32 v67, v66, v65, s80
    v_perm_b32 v67, v67, v64, s81
    v_perm_b32 v75, v74, v73, s80
    v_perm_b32 v75, v75, v72, s81
    v_perm_b32 v83, v82, v81, s80
    v_perm_b32 v83, v83, v80, s81
    v_mov_b32 v10, v18
    v_max_f32 v10, v10, v28
    v_max_f32 v10, v10, v36
    v_max_f32 v10, v10, v44
    v_max_f32 v10, v10, v52
    v_max_f32 v10, v10, v60
    v_max_f32 v10, v10, v68
    v_max_f32 v10, v10, v76
    v_max_f32 v10, v10, v84
    v_sub_f32 v11, v18, v10
    v_exp_f32 v11, v11
    v_sub_f32 v28, v28, v10
    v_sub_f32 v36, v36, v10
    v_sub_f32 v44, v44, v10
    v_sub_f32 v52, v52, v10
    v_sub_f32 v60, v60, v10
    v_sub_f32 v68, v68, v10
    v_sub_f32 v76, v76, v10
    v_sub_f32 v84, v84, v10
    v_exp_f32 v28, v28
    v_exp_f32 v36, v36
    v_exp_f32 v44, v44
    v_exp_f32 v52, v52
    v_exp_f32 v60, v60
    v_exp_f32 v68, v68
    v_exp_f32 v76, v76
    v_exp_f32 v84, v84
    v_mov_b32 v18, v10
    v_mul_f32 v19, v19, v11
    v_mul_f32 v20, v20, v11
    v_mul_f32 v21, v21, v11
    v_mul_f32 v22, v22, v11
    v_mul_f32 v23, v23, v11
    v_fmac_f32 v19, v29, v28
    v_fmac_f32 v20, v24, v28
    v_fmac_f32 v21, v25, v28
    v_fmac_f32 v22, v26, v28
    v_fmac_f32 v23, v27, v28
    v_fmac_f32 v19, v37, v36
    v_fmac_f32 v20, v32, v36
    v_fmac_f32 v21, v33, v36
    v_fmac_f32 v22, v34, v36
    v_fmac_f32 v23, v35, v36
    v_fmac_f32 v19, v45, v44
    v_fmac_f32 v20, v40, v44
    v_fmac_f32 v21, v41, v44
    v_fmac_f32 v22, v42, v44
    v_fmac_f32 v23, v43, v44
    v_fmac_f32 v19, v53, v52
    v_fmac_f32 v20, v48, v52
    v_fmac_f32 v21, v49, v52
    v_fmac_f32 v22, v50, v52
    v_fmac_f32 v23, v51, v52
    v_fmac_f32 v19, v61, v60
    v_fmac_f32 v20, v56, v60
    v_fmac_f32 v21, v57, v60
    v_fmac_f32 v22, v58, v60
    v_fmac_f32 v23, v59, v60
    v_fmac_f32 v19, v69, v68
    v_fmac_f32 v20, v64, v68
    v_fmac_f32 v21, v65, v68
    v_fmac_f32 v22, v66, v68
    v_fmac_f32 v23, v67, v68
    v_fmac_f32 v19, v77, v76
    v_fmac_f32 v20, v72, v76
    v_fmac_f32 v21, v73, v76
    v_fmac_f32 v22, v74, v76
    v_fmac_f32 v23, v75, v76
    v_fmac_f32 v19, v85, v84
    v_fmac_f32 v20, v80, v84
    v_fmac_f32 v21, v81, v84
    v_fmac_f32 v22, v82, v84
    v_fmac_f32 v23, v83, v84
    s_cmp_le_u32 s58, 8
    s_cbranch_scc1 L_sv_final
    v_perm_b32 v91, v90, v89, s80
    v_perm_b32 v91, v91, v88, s81
    v_perm_b32 v99, v98, v97, s80
    v_perm_b32 v99, v99, v96, s81
    v_perm_b32 v107, v106, v105, s80
    v_perm_b32 v107, v107, v104, s81
    v_perm_b32 v115, v114, v113, s80
    v_perm_b32 v115, v115, v112, s81
    v_perm_b32 v123, v122, v121, s80
    v_perm_b32 v123, v123, v120, s81
    v_perm_b32 v131, v130, v129, s80
    v_perm_b32 v131, v131, v128, s81
    v_perm_b32 v139, v138, v137, s80
    v_perm_b32 v139, v139, v136, s81
    v_perm_b32 v147, v146, v145, s80
    v_perm_b32 v147, v147, v144, s81
    v_mov_b32 v10, v18
    v_max_f32 v10, v10, v92
    v_max_f32 v10, v10, v100
    v_max_f32 v10, v10, v108
    v_max_f32 v10, v10, v116
    v_max_f32 v10, v10, v124
    v_max_f32 v10, v10, v132
    v_max_f32 v10, v10, v140
    v_max_f32 v10, v10, v148
    v_sub_f32 v11, v18, v10
    v_exp_f32 v11, v11
    v_sub_f32 v92, v92, v10
    v_sub_f32 v100, v100, v10
    v_sub_f32 v108, v108, v10
    v_sub_f32 v116, v116, v10
    v_sub_f32 v124, v124, v10
    v_sub_f32 v132, v132, v10
    v_sub_f32 v140, v140, v10
    v_sub_f32 v148, v148, v10
    v_exp_f32 v92, v92
    v_exp_f32 v100, v100
    v_exp_f32 v108, v108
    v_exp_f32 v116, v116
    v_exp_f32 v124, v124
    v_exp_f32 v132, v132
    v_exp_f32 v140, v140
    v_exp_f32 v148, v148
    v_mov_b32 v18, v10
    v_mul_f32 v19, v19, v11
    v_mul_f32 v20, v20, v11
    v_mul_f32 v21, v21, v11
    v_mul_f32 v22, v22, v11
    v_mul_f32 v23, v23, v11
    v_fmac_f32 v19, v93, v92
    v_fmac_f32 v20, v88, v92
    v_fmac_f32 v21, v89, v92
    v_fmac_f32 v22, v90, v92
    v_fmac_f32 v23, v91, v92
    v_fmac_f32 v19, v101, v100
    v_fmac_f32 v20, v96, v100
    v_fmac_f32 v21, v97, v100
    v_fmac_f32 v22, v98, v100
    v_fmac_f32 v23, v99, v100
    v_fmac_f32 v19, v109, v108
    v_fmac_f32 v20, v104, v108
    v_fmac_f32 v21, v105, v108
    v_fmac_f32 v22, v106, v108
    v_fmac_f32 v23, v107, v108
    v_fmac_f32 v19, v117, v116
    v_fmac_f32 v20, v112, v116
    v_fmac_f32 v21, v113, v116
    v_fmac_f32 v22, v114, v116
    v_fmac_f32 v23, v115, v116
    v_fmac_f32 v19, v125, v124
    v_fmac_f32 v20, v120, v124
    v_fmac_f32 v21, v121, v124
    v_fmac_f32 v22, v122, v124
    v_fmac_f32 v23, v123, v124
    v_fmac_f32 v19, v133, v132
    v_fmac_f32 v20, v128, v132
    v_fmac_f32 v21, v129, v132
    v_fmac_f32 v22, v130, v132
    v_fmac_f32 v23, v131, v132
    v_fmac_f32 v19, v141, v140
    v_fmac_f32 v20, v136, v140
    v_fmac_f32 v21, v137, v140
    v_fmac_f32 v22, v138, v140
    v_fmac_f32 v23, v139, v140
    v_fmac_f32 v19, v149, v148
    v_fmac_f32 v20, v144, v148
    v_fmac_f32 v21, v145, v148
    v_fmac_f32 v22, v146, v148
    v_fmac_f32 v23, v147, v148
    s_cmp_lg_u32 s82, 0
    s_cbranch_scc1 L_sv_batch
L_sv_final:
    v_bfe_u32 v12, v1, 3, 1
    v_lshlrev_b32 v12, 8, v12
    v_lshrrev_b32 v13, 4, v1
    v_lshl_add_u32 v12, v13, 6, v12
    v_and_b32 v13, 7, v1
    v_lshl_add_u32 v12, v13, 1, v12
    s_lshl_b32 s59, s37, 13
    s_lshl_b32 s60, s36, 9
    s_add_u32 s59, s59, s60
    s_and_b32 s56, s26, 3
    s_cmp_eq_u32 s42, 17
    s_cselect_b32 s56, 4, s56
    s_mul_i32 s56, s56, 3264
    s_add_u32 s56, s56, 12400
    v_add_u32 v8, s56, v17
    v_add_u32 v9, s56, v16
    s_barrier
    ds_read_b128 v[24:27], v8 offset:0
    ds_read_b64 v[28:29], v9 offset:1024
    ds_read_b128 v[32:35], v8 offset:1088
    ds_read_b64 v[36:37], v9 offset:2112
    ds_read_b128 v[40:43], v8 offset:2176
    ds_read_b64 v[44:45], v9 offset:3200
    ds_read_b128 v[48:51], v8 offset:3264
    ds_read_b64 v[52:53], v9 offset:4288
    s_waitcnt lgkmcnt(0)
    v_mov_b32 v10, v18
    v_max_f32 v10, v10, v28
    v_max_f32 v10, v10, v36
    v_max_f32 v10, v10, v44
    v_max_f32 v10, v10, v52
    v_sub_f32 v11, v18, v10
    v_exp_f32 v11, v11
    v_sub_f32 v28, v28, v10
    v_sub_f32 v36, v36, v10
    v_sub_f32 v44, v44, v10
    v_sub_f32 v52, v52, v10
    v_exp_f32 v28, v28
    v_exp_f32 v36, v36
    v_exp_f32 v44, v44
    v_exp_f32 v52, v52
    v_mov_b32 v18, v10
    v_mul_f32 v19, v19, v11
    v_mul_f32 v20, v20, v11
    v_mul_f32 v21, v21, v11
    v_mul_f32 v22, v22, v11
    v_mul_f32 v23, v23, v11
    v_fmac_f32 v19, v29, v28
    v_fmac_f32 v20, v24, v28
    v_fmac_f32 v21, v25, v28
    v_fmac_f32 v22, v26, v28
    v_fmac_f32 v23, v27, v28
    v_fmac_f32 v19, v37, v36
    v_fmac_f32 v20, v32, v36
    v_fmac_f32 v21, v33, v36
    v_fmac_f32 v22, v34, v36
    v_fmac_f32 v23, v35, v36
    v_fmac_f32 v19, v45, v44
    v_fmac_f32 v20, v40, v44
    v_fmac_f32 v21, v41, v44
    v_fmac_f32 v22, v42, v44
    v_fmac_f32 v23, v43, v44
    v_fmac_f32 v19, v53, v52
    v_fmac_f32 v20, v48, v52
    v_fmac_f32 v21, v49, v52
    v_fmac_f32 v22, v50, v52
    v_fmac_f32 v23, v51, v52
    v_mov_b32 v10, v19
    s_nop 1
    v_permlane32_swap_b32 v19, v10
    v_add_f32 v19, v19, v10
    v_mov_b32 v10, v19
    s_nop 1
    v_permlane16_swap_b32 v19, v10
    v_add_f32 v19, v19, v10
    v_rcp_f32 v10, v19
    s_nop 0
    v_mul_f32 v20, v20, v10
    v_mul_f32 v21, v21, v10
    v_mul_f32 v22, v22, v10
    v_mul_f32 v23, v23, v10
    v_cvt_pk_bf16_f32 v20, v20, v21
    v_cvt_pk_bf16_f32 v22, v22, v23
    buffer_store_short v20, v12, s[32:35], s59 offen
    buffer_store_short_d16_hi v20, v12, s[32:35], s59 offen offset:16
    buffer_store_short v22, v12, s[32:35], s59 offen offset:32
    buffer_store_short_d16_hi v22, v12, s[32:35], s59 offen offset:48
L_exit:
    s_endpgm
.p2align 6
.type L_hint,@object
L_hint:
    .long 0x445700ab, 0x44570110, 0x445501b4, 0x44290200, 0x440f0298, 0x44150300, 0x444b0380, 0x440f0407, 0x44370480, 0x440f0511, 0x44230580, 0x440f061b, 0x440f0680, 0x44430700, 0x440f0789, 0x8010080
.section .rodata,"a"
.p2align 6
.amdhsa_kernel standalone__paged_block_table_kv_radixattention__sampling_kernel
  .amdhsa_next_free_vgpr 176
  .amdhsa_next_free_sgpr 102
  .amdhsa_accum_offset 176
  .amdhsa_group_segment_fixed_size 0
  .amdhsa_kernarg_size 64
  .amdhsa_user_sgpr_count 2
  .amdhsa_user_sgpr_kernarg_segment_ptr 1
  .amdhsa_system_sgpr_workgroup_id_x 1
.end_amdhsa_kernel
```
